```python
import torch

def _softmax(x, axis=-1):
    return torch.softmax(x, dim=axis)
def _gelu(x):
    return torch.nn.functional.gelu(x, approximate="tanh")
def _silu(x):
    return torch.nn.functional.silu(x)
def _sigmoid(x):
    return torch.sigmoid(x)
def _layernorm(x, axis=-1, eps=1e-5):
    m = x.mean(dim=axis, keepdim=True)
    v = x.var(dim=axis, keepdim=True, unbiased=False)
    return (x - m) / torch.sqrt(v + eps)
def _scatter_add(tgt, idx, src, axis=0):
    return tgt.clone().index_add_(axis, idx, src)
def _segment_sum(src, seg, n):
    out = torch.zeros((n,) + src.shape[1:], dtype=src.dtype)
    return out.index_add_(0, seg, src)
def _pad(x, pw):
    flat = tuple(v for pair in reversed(pw) for v in pair)
    return torch.nn.functional.pad(x, flat)

kernel_name = 'standalone__edge_featured_mpnn_gatedgcn__graph'

def setup_inputs():

    _w = (lambda a: (lambda t: t.to(torch.bfloat16) if t.is_floating_point() else t)(torch.as_tensor(a)))
    N, deg, D, De = 10000, 16, 128, max(4, 1)
    E = N * deg
    return {
        "x": _w((lambda *s: torch.randn(*s, dtype=torch.bfloat16) * 0.4)(N, D)),
        "e_attr": _w((lambda *s: torch.randn(*s, dtype=torch.bfloat16) * 0.8)(E, De)),
        "src": _w((lambda lo, hi, *s: torch.randint(lo, hi, s))(0, N, E).to(torch.int64)),
        "dst": _w((lambda lo, hi, *s: torch.randint(lo, hi, s))(0, N, E).to(torch.int64)),
        "w_a": _w((lambda *s: torch.randn(*s, dtype=torch.bfloat16) * 0.4)(D, D)),
        "w_b": _w((lambda *s: torch.randn(*s, dtype=torch.bfloat16) * 0.4)(D, D)),
        "w_c": _w((lambda *s: torch.randn(*s, dtype=torch.bfloat16) * 0.8)(De, D)),
        "w_u": _w((lambda *s: torch.randn(*s, dtype=torch.bfloat16) * 0.05)(D, D)),
        "w_v": _w((lambda *s: torch.randn(*s, dtype=torch.bfloat16) * 0.05)(D, D)),
    }

def reference(x, e_attr, src, dst, w_a, w_b, w_c, w_u, w_v):
    N, D = x.shape
    hv = x @ w_v
    g = x[dst] @ w_a + x[src] @ w_b + e_attr @ w_c
    eta = _sigmoid(g)
    denom = _segment_sum(eta, dst, N) + 1e-6
    eta_n = eta / denom[dst]
    agg = _segment_sum(eta_n * hv[src], dst, N)
    z = x @ w_u + agg
    relu_z = torch.where(z > 0, z, 0 * z)
    return x + relu_z
```

```asm
; @launch grid=(256,1,1) block=(1024,1,1) lds=150272
.amdgcn_target "amdgcn-amd-amdhsa--gfx950"
.text
.globl standalone__edge_featured_mpnn_gatedgcn__graph_kernel
.p2align 12
.p2align 8
.type standalone__edge_featured_mpnn_gatedgcn__graph_kernel,@function
standalone__edge_featured_mpnn_gatedgcn__graph_kernel:
  s_cmp_ge_u32 s2, 256
  s_cbranch_scc1 KEND
  s_load_dwordx16 s[40:55], s[0:1], 0
  v_readfirstlane_b32 s33, v0
  s_load_dwordx8 s[56:63], s[0:1], 64
  s_load_dwordx2 s[4:5], s[0:1], 0
  v_and_b32 v124, 63, v0
  s_lshr_b32 s33, s33, 6
  s_cbranch_scc1 LD0
  s_setprio 3
  s_mul_i32 s38, s2, 2560
  s_mov_b32 s39, 116480
  v_mov_b32 v42, 0
  v_mov_b32 v43, 0
  v_lshl_add_u32 v100, v0, 3, s39
  v_lshl_add_u32 v2, v0, 3, s38
  ds_write_b64 v100, v[42:43]
  v_lshlrev_b32 v3, 1, v2
  v_add_u32 v3, 0x400, v3
  s_mov_b32 s7, 0x00020000
  s_cmp_ge_u32 s2, 250
  s_waitcnt lgkmcnt(0)
  s_load_dwordx2 s[12:13], s[62:63], 0
  s_cbranch_scc1 NOBIN
  global_load_dwordx2 v[32:33], v2, s[46:47] offset:0
  global_load_dwordx2 v[34:35], v2, s[46:47] offset:512
  global_load_dwordx2 v[36:37], v2, s[46:47] offset:1024
  global_load_dwordx2 v[38:39], v2, s[46:47] offset:1536
  global_load_dwordx2 v[40:41], v2, s[46:47] offset:2048
  global_load_dwordx2 v[50:51], v2, s[44:45] offset:0
  global_load_dwordx4 v[60:63], v3, s[42:43] offset:-1024
  global_load_dwordx2 v[52:53], v2, s[44:45] offset:512
  global_load_dwordx4 v[64:67], v3, s[42:43] offset:0
  global_load_dwordx2 v[54:55], v2, s[44:45] offset:1024
  global_load_dwordx4 v[68:71], v3, s[42:43] offset:1024
  global_load_dwordx2 v[56:57], v2, s[44:45] offset:1536
  global_load_dwordx4 v[72:75], v3, s[42:43] offset:2048
  global_load_dwordx2 v[58:59], v2, s[44:45] offset:2048
  global_load_dwordx4 v[76:79], v3, s[42:43] offset:3072
  s_barrier
  s_branch BIN1
LD0:
  s_mov_b32 s6, 2560000
  s_mov_b32 s7, 0x00020000
  s_cmp_ge_u32 s33, 5
  s_cbranch_scc1 OTH
  s_setprio 2
  s_bfe_u32 s30, s2, 0x10002
  s_and_b32 s34, s2, 3
  s_lshr_b32 s32, s2, 3
  s_lshl_b32 s31, s34, 5
  s_add_u32 s31, s31, s32
  s_lshl_b32 s35, s31, 8
  s_and_b32 s36, s33, 3
  v_lshlrev_b32 v2, 1, v124
  v_lshlrev_b32 v1, 4, v124
  v_and_b32 v2, 0x20, v2
  v_and_b32 v1, 0x70, v1
  s_mul_i32 s38, s36, 2112
  v_xor_b32 v2, v2, v1
  v_lshrrev_b32 v1, 3, v124
  s_and_b32 s38, s38, 6208
  s_lshl_b32 s39, s30, 7
  v_lshl_or_b32 v1, v1, 8, v2
  s_or_b32 s38, s38, s39
  v_xor_b32 v1, s38, v1
  s_movk_i32 s26, 7168
  s_movk_i32 s27, 14336
  s_movk_i32 s28, 21504
  v_bfe_u32 v9, v0, 4, 4
  s_lshl_b32 s37, s36, 12
  v_xor_b32 v10, v9, v0
  s_add_u32 m0, s37, 25600
  v_and_b32 v10, 15, v10
  s_mov_b32 s66, 32768
  v_lshlrev_b32 v10, 4, v10
  s_mov_b32 s67, s7
  v_lshl_or_b32 v9, v9, 15, v10
  s_mov_b64 s[70:71], s[66:67]
  s_lshl_b32 s36, s36, 10
  s_waitcnt lgkmcnt(0)
  s_mov_b64 s[64:65], s[50:51]
  s_mov_b64 s[68:69], s[56:57]
  s_barrier
  s_add_u32 m0, s36, 0
  s_add_u32 s38, s35, 0
  buffer_load_dwordx4 v9, s[4:7], s38 offen lds
  s_add_u32 m0, s36, 4096
  s_add_u32 s38, s35, 524288
  buffer_load_dwordx4 v9, s[4:7], s38 offen lds
  s_add_u32 m0, s36, 8192
  s_add_u32 s38, s35, 1048576
  buffer_load_dwordx4 v9, s[4:7], s38 offen lds
  s_add_u32 m0, s36, 12288
  s_add_u32 s38, s35, 1572864
  buffer_load_dwordx4 v9, s[4:7], s38 offen lds
  s_add_u32 m0, s36, 16384
  s_add_u32 s38, s35, 2097152
  buffer_load_dwordx4 v9, s[4:7], s38 offen lds
  v_mov_b32 v23, 0
  v_mov_b32 v2, 1
  s_mov_b64 exec, 1
  ds_add_u32 v23, v2 offset:22892
  s_mov_b64 exec, -1
  s_mov_b32 s39, 0x200000
LDS0:
  ds_read_b32 v120, v23 offset:22892
  s_sub_u32 s39, s39, 1
  s_cbranch_scc1 LDS0X
  s_waitcnt lgkmcnt(0)
  v_cmp_ne_u32 vcc, 4, v120
  s_cbranch_vccnz LDS0
LDS0X:
  s_add_u32 m0, s37, 25600
  s_nop 0
  buffer_load_dwordx4 v1, s[64:67], 0 offen offset:0 lds
  buffer_load_dwordx4 v1, s[64:67], s26 offen offset:1024 lds
  buffer_load_dwordx4 v1, s[64:67], s27 offen offset:2048 lds
  buffer_load_dwordx4 v1, s[64:67], s28 offen offset:3072 lds
  s_add_u32 m0, s37, 41984
  s_nop 0
  buffer_load_dwordx4 v1, s[68:71], 0 offen offset:0 lds
  buffer_load_dwordx4 v1, s[68:71], s26 offen offset:1024 lds
  buffer_load_dwordx4 v1, s[68:71], s27 offen offset:2048 lds
  buffer_load_dwordx4 v1, s[68:71], s28 offen offset:3072 lds
  v_mov_b32 v23, 0
  v_mov_b32 v2, 1
  s_mov_b64 exec, 1
  ds_add_u32 v23, v2 offset:22896
  s_waitcnt vmcnt(12)
  ds_add_u32 v23, v2 offset:22852
  s_waitcnt vmcnt(11)
  ds_add_u32 v23, v2 offset:22856
  s_waitcnt vmcnt(10)
  ds_add_u32 v23, v2 offset:22860
  s_waitcnt vmcnt(9)
  ds_add_u32 v23, v2 offset:22864
  s_waitcnt vmcnt(8)
  ds_add_u32 v23, v2 offset:22868
  s_waitcnt vmcnt(0)
  ds_add_u32 v23, v2 offset:22848
  s_mov_b64 exec, -1
  s_setprio 0
  s_branch COM
NOBIN:
  s_barrier
  s_waitcnt lgkmcnt(0)
  s_and_b32 s8, s12, 0xfff80000
  s_add_u32 s8, s8, 0x80000
  s_addc_u32 s9, s13, 0
  s_lshr_b64 s[10:11], s[8:9], 19
  s_mul_i32 s10, s10, 0x9e3779b1
  s_branch BINE
BIN1:
  v_mov_b32 v101, 16
  s_mul_i32 s38, s2, 10368
  s_add_u32 s38, s38, 524288
  s_add_u32 s64, s62, s38
  s_addc_u32 s65, s63, 0
  s_movk_i32 s66, 10240
  s_mov_b32 s67, s7
  s_movk_i32 s38, 4096
  s_movk_i32 s37, 8192
  s_lshl_b32 s36, s2, 6
  s_add_u32 s36, s36, 65536
  v_and_b32 v3, 7, v0
  v_lshrrev_b32 v4, 3, v0
  v_lshl_add_u32 v3, v3, 3, s36
  v_lshl_add_u32 v3, v4, 14, v3
  v_lshlrev_b32 v1, 4, v0
  v_add_u32 v2, 106240, v1
  s_waitcnt vmcnt(14)
  v_and_b32 v90, 0x7f, v32
  v_lshl_add_u32 v90, v90, 2, s39
  ds_add_rtn_u32 v80, v90, v101
  v_and_b32 v91, 0x7f, v33
  v_lshl_add_u32 v91, v91, 2, s39
  ds_add_rtn_u32 v81, v91, v101
  s_waitcnt vmcnt(13)
  v_and_b32 v92, 0x7f, v34
  v_lshl_add_u32 v92, v92, 2, s39
  ds_add_rtn_u32 v82, v92, v101
  v_and_b32 v93, 0x7f, v35
  v_lshl_add_u32 v93, v93, 2, s39
  ds_add_rtn_u32 v83, v93, v101
  s_waitcnt vmcnt(12)
  v_and_b32 v94, 0x7f, v36
  v_lshl_add_u32 v94, v94, 2, s39
  ds_add_rtn_u32 v84, v94, v101
  v_and_b32 v95, 0x7f, v37
  v_lshl_add_u32 v95, v95, 2, s39
  ds_add_rtn_u32 v85, v95, v101
  s_waitcnt vmcnt(11)
  v_and_b32 v96, 0x7f, v38
  v_lshl_add_u32 v96, v96, 2, s39
  ds_add_rtn_u32 v86, v96, v101
  v_and_b32 v97, 0x7f, v39
  v_lshl_add_u32 v97, v97, 2, s39
  ds_add_rtn_u32 v87, v97, v101
  s_waitcnt vmcnt(10)
  v_and_b32 v98, 0x7f, v40
  v_lshl_add_u32 v98, v98, 2, s39
  ds_add_rtn_u32 v88, v98, v101
  v_and_b32 v99, 0x7f, v41
  v_lshl_add_u32 v99, v99, 2, s39
  ds_add_rtn_u32 v89, v99, v101
  ds_read_b64 v[42:43], v100
  v_lshrrev_b32 v32, 7, v32
  v_lshrrev_b32 v33, 7, v33
  v_lshrrev_b32 v34, 7, v34
  v_lshrrev_b32 v35, 7, v35
  v_lshrrev_b32 v36, 7, v36
  v_lshrrev_b32 v37, 7, v37
  v_lshrrev_b32 v38, 7, v38
  v_lshrrev_b32 v39, 7, v39
  v_lshrrev_b32 v40, 7, v40
  v_lshrrev_b32 v41, 7, v41
  s_waitcnt lgkmcnt(0)
  v_add_u32 v44, v42, v43
  v_subrev_u32 v49, 106240, v43
  v_subrev_u32 v48, 106240, v44
  v_add_u32_dpp v45, v44, v44 row_shr:1 row_mask:0xf bank_mask:0xf bound_ctrl:0
  s_and_b32 s8, s12, 0xfff80000
  s_add_u32 s8, s8, 0x80000
  v_add_u32_dpp v45, v45, v45 row_shr:2 row_mask:0xf bank_mask:0xf bound_ctrl:0
  s_addc_u32 s9, s13, 0
  s_lshr_b64 s[10:11], s[8:9], 19
  v_add_u32_dpp v45, v45, v45 row_shr:4 row_mask:0xf bank_mask:0xf bound_ctrl:0
  s_mul_i32 s10, s10, 0x9e3779b1
  s_mov_b32 s11, 4288161296
  v_add_u32_dpp v45, v45, v45 row_shr:8 row_mask:0xf bank_mask:0xf bound_ctrl:0
  v_mov_b32 v103, s10
  v_mov_b32 v105, s10
  v_add_u32_dpp v45, v45, v45 row_bcast:15 row_mask:0xa bank_mask:0xf
  v_mov_b32 v107, s10
  v_mov_b32 v109, s10
  v_add_u32_dpp v45, v45, v45 row_bcast:31 row_mask:0xc bank_mask:0xf
  v_sub_u32 v46, v45, v48
  v_sub_u32 v47, v45, v49
  ds_write_b64 v100, v[46:47] offset:512
  ds_read_b32 v90, v90 offset:512
  ds_read_b32 v91, v91 offset:512
  ds_read_b32 v92, v92 offset:512
  ds_read_b32 v93, v93 offset:512
  ds_read_b32 v94, v94 offset:512
  ds_read_b32 v95, v95 offset:512
  ds_read_b32 v96, v96 offset:512
  ds_read_b32 v97, v97 offset:512
  ds_read_b32 v98, v98 offset:512
  ds_read_b32 v99, v99 offset:512
  v_lshl_add_u32 v42, v45, 16, s11
  v_lshrrev_b32 v44, 4, v46
  v_lshl_add_u32 v42, v47, 6, v42
  v_mov_b32 v43, s10
  v_add_u32 v42, v42, v44
  v_mov_b32 v111, s10
  v_mov_b32 v113, s10
  v_mov_b32 v115, s10
  v_mov_b32 v117, s10
  v_mov_b32 v119, s10
  v_mov_b32 v121, s10
  s_waitcnt vmcnt(8)
  v_lshl_or_b32 v102, v32, 18, v50
  s_waitcnt lgkmcnt(9)
  v_add_u32 v90, v90, v80
  ds_write2_b64 v90, v[60:61], v[102:103] offset0:0 offset1:1
  v_lshl_or_b32 v104, v33, 18, v51
  s_waitcnt lgkmcnt(9)
  v_add_u32 v91, v91, v81
  ds_write2_b64 v91, v[62:63], v[104:105] offset0:0 offset1:1
  s_waitcnt vmcnt(6)
  v_lshl_or_b32 v106, v34, 18, v52
  s_waitcnt lgkmcnt(9)
  v_add_u32 v92, v92, v82
  ds_write2_b64 v92, v[64:65], v[106:107] offset0:0 offset1:1
  v_lshl_or_b32 v108, v35, 18, v53
  s_waitcnt lgkmcnt(9)
  v_add_u32 v93, v93, v83
  ds_write2_b64 v93, v[66:67], v[108:109] offset0:0 offset1:1
  s_waitcnt vmcnt(4)
  v_lshl_or_b32 v110, v36, 18, v54
  s_waitcnt lgkmcnt(9)
  v_add_u32 v94, v94, v84
  ds_write2_b64 v94, v[68:69], v[110:111] offset0:0 offset1:1
  v_lshl_or_b32 v112, v37, 18, v55
  s_waitcnt lgkmcnt(9)
  v_add_u32 v95, v95, v85
  ds_write2_b64 v95, v[70:71], v[112:113] offset0:0 offset1:1
  s_waitcnt vmcnt(2)
  v_lshl_or_b32 v114, v38, 18, v56
  s_waitcnt lgkmcnt(9)
  v_add_u32 v96, v96, v86
  ds_write2_b64 v96, v[72:73], v[114:115] offset0:0 offset1:1
  v_lshl_or_b32 v116, v39, 18, v57
  s_waitcnt lgkmcnt(9)
  v_add_u32 v97, v97, v87
  ds_write2_b64 v97, v[74:75], v[116:117] offset0:0 offset1:1
  s_waitcnt vmcnt(0)
  v_lshl_or_b32 v118, v40, 18, v58
  s_waitcnt lgkmcnt(9)
  v_add_u32 v98, v98, v88
  ds_write2_b64 v98, v[76:77], v[118:119] offset0:0 offset1:1
  v_lshl_or_b32 v120, v41, 18, v59
  s_waitcnt lgkmcnt(9)
  v_add_u32 v99, v99, v89
  ds_write2_b64 v99, v[78:79], v[120:121] offset0:0 offset1:1
  ds_read_b128 v[60:63], v2 offset:0
  ds_read_b128 v[64:67], v2 offset:1024
  ds_read_b128 v[68:71], v2 offset:2048
  ds_read_b128 v[72:75], v2 offset:3072
  ds_read_b128 v[76:79], v2 offset:4096
  ds_read_b128 v[80:83], v2 offset:5120
  ds_read_b128 v[84:87], v2 offset:6144
  ds_read_b128 v[88:91], v2 offset:7168
  ds_read_b128 v[92:95], v2 offset:8192
  ds_read_b128 v[96:99], v2 offset:9216
  v_mov_b32 v23, 0
  s_mov_b32 s39, 0x200000
BGS:
  ds_read_b32 v120, v23 offset:22896
  s_sub_u32 s39, s39, 1
  s_cbranch_scc1 BGSX
  s_waitcnt lgkmcnt(0)
  v_cmp_ne_u32 vcc, 4, v120
  s_cbranch_vccnz BGS
BGSX:
  global_store_dwordx2 v3, v[42:43], s[62:63] sc1
  s_waitcnt lgkmcnt(9)
  buffer_store_dwordx4 v[60:63], v1, s[64:67], 0 offen offset:0 sc1
  s_waitcnt lgkmcnt(8)
  buffer_store_dwordx4 v[64:67], v1, s[64:67], 0 offen offset:1024 sc1
  s_waitcnt lgkmcnt(7)
  buffer_store_dwordx4 v[68:71], v1, s[64:67], 0 offen offset:2048 sc1
  s_waitcnt lgkmcnt(6)
  buffer_store_dwordx4 v[72:75], v1, s[64:67], 0 offen offset:3072 sc1
  s_waitcnt lgkmcnt(5)
  buffer_store_dwordx4 v[76:79], v1, s[64:67], s38 offen offset:0 sc1
  s_waitcnt lgkmcnt(4)
  buffer_store_dwordx4 v[80:83], v1, s[64:67], s38 offen offset:1024 sc1
  s_waitcnt lgkmcnt(3)
  buffer_store_dwordx4 v[84:87], v1, s[64:67], s38 offen offset:2048 sc1
  s_waitcnt lgkmcnt(2)
  buffer_store_dwordx4 v[88:91], v1, s[64:67], s38 offen offset:3072 sc1
  s_waitcnt lgkmcnt(1)
  buffer_store_dwordx4 v[92:95], v1, s[64:67], s37 offen offset:0 sc1
  s_waitcnt lgkmcnt(0)
  buffer_store_dwordx4 v[96:99], v1, s[64:67], s37 offen offset:1024 sc1
BINE:
  s_setprio 0
  v_mov_b32 v23, 0
  v_mov_b32 v36, s8
  v_mov_b32 v37, s9
  v_mov_b32 v38, s12
  v_mov_b32 v39, s13
  v_mov_b32 v40, s10
  s_mov_b64 exec, 1
  ds_write_b128 v23, v[36:39] offset:22928
  ds_write_b32 v23, v40 offset:22944
  s_mov_b64 exec, -1
  s_mov_b32 s6, 2560000
  s_bfe_u32 s30, s2, 0x10002
  s_and_b32 s34, s2, 3
  s_lshr_b32 s32, s2, 3
  s_lshl_b32 s31, s34, 5
  s_add_u32 s31, s31, s32
  s_lshl_b32 s35, s31, 8
  s_branch COM
OTH:
  s_cmp_lt_u32 s33, 7
  s_cselect_b32 s39, 100, 0
  s_cselect_b32 s38, -32000, 0
  s_cmp_eq_u32 s33, 7
  s_cselect_b32 s38, 1158035389, s38
  s_cmp_eq_u32 s33, 8
  s_cselect_b32 s38, 7900, s38
  v_mul_u32_u24 v57, s39, v0
  s_lshl_b32 m0, s33, 8
  v_add_u32 v57, s38, v57
  v_mov_b32 v58, 0
  ds_write_addtid_b32 v57 offset:20224
  v_mov_b32 v57, 0x27102710
  s_bfe_u32 s30, s2, 0x10002
  s_and_b32 s34, s2, 3
  s_lshr_b32 s32, s2, 3
  s_lshl_b32 s31, s34, 5
  s_add_u32 s31, s31, s32
  s_lshl_b32 s35, s31, 8
  s_cmp_ge_u32 s33, 8
  v_and_b32 v1, 15, v0
  s_cbranch_scc1 FILL
  s_getpc_b64 s[38:39]
  s_lshl_b32 s37, s32, 9
  s_and_b32 s38, s38, 0xfffff000
  v_lshl_add_u32 v2, v124, 7, s37
  v_mov_b32 v3, 0
  v_lshl_add_u64 v[2:3], v[2:3], 0, s[38:39]
  s_mov_b64 exec, 15
  global_load_dword v44, v[2:3], off
  s_mov_b64 exec, -1
  v_lshrrev_b32 v2, 4, v124
  s_lshl_b32 s36, s30, 7
  v_lshl_or_b32 v1, v1, 2, v2
  v_lshl_add_u32 v1, v1, 1, s36
  s_lshl_b32 s37, s32, 10
  s_add_u32 s37, s37, s36
  v_lshl_add_u32 v47, v124, 8, s37
  s_cmp_eq_u32 s33, 6
  s_waitcnt lgkmcnt(0)
  s_cselect_b64 s[38:39], s[50:51], s[56:57]
  s_mov_b64 exec, 15
  global_load_dword v46, v47, s[38:39]
  s_mov_b64 exec, -1
  s_barrier
  s_cmp_lg_u32 s33, 5
  s_cbranch_scc1 WPF
  global_load_ushort v40, v1, s[52:53] offset:0
  global_load_ushort v41, v1, s[52:53] offset:256
  global_load_ushort v42, v1, s[52:53] offset:512
  global_load_ushort v43, v1, s[52:53] offset:768
  s_branch COM
WPF:
  s_cmp_eq_u32 s33, 6
  s_cselect_b64 s[38:39], s[48:49], s[54:55]
  s_lshl_b32 s37, s32, 10
  s_add_u32 s37, s37, s36
  v_lshl_add_u32 v1, v124, 8, s37
  s_mov_b64 exec, 15
  global_load_dword v45, v1, s[38:39]
  s_mov_b64 exec, -1
  s_branch COM
FILL:
  s_add_u32 m0, m0, 40960
  s_mul_i32 s38, s31, 0x10001
  s_add_u32 s38, s38, 0x27802780
  v_mov_b32 v57, s38
  s_waitcnt lgkmcnt(0)
  s_barrier
  ds_write_addtid_b32 v57 offset:22272
  ds_write_addtid_b32 v57 offset:24320
  ds_write_addtid_b32 v57 offset:26368
  ds_write_addtid_b32 v57 offset:28416
  ds_write_addtid_b32 v58 offset:30464
  ds_write_addtid_b32 v58 offset:32512
  ds_write_addtid_b32 v58 offset:34560
  ds_write_addtid_b32 v58 offset:36608
  ds_write_addtid_b32 v58 offset:38656
  ds_write_addtid_b32 v58 offset:40704
  ds_write_addtid_b32 v58 offset:42752
  ds_write_addtid_b32 v58 offset:44800
  ds_write_addtid_b32 v58 offset:46848
  ds_write_addtid_b32 v58 offset:48896
  ds_write_addtid_b32 v58 offset:50944
  ds_write_addtid_b32 v58 offset:52992
  ds_write_addtid_b32 v58 offset:55040
  ds_write_addtid_b32 v58 offset:57088
  ds_write_addtid_b32 v58 offset:59136
  ds_write_addtid_b32 v58 offset:61184
COM:
  s_mov_b64 s[24:25], s[62:63]
  s_mov_b64 s[20:21], s[58:59]
  s_lshl_b32 s36, s30, 7
  s_mul_i32 s39, s30, 2621440
  s_add_u32 s39, s39, 3145728
  s_add_u32 s16, s24, s39
  s_addc_u32 s17, s25, 0
  s_mov_b64 s[14:15], s[16:17]
  s_or_b32 s17, s17, 16777216
  s_mov_b32 s18, 10240
  s_mov_b32 s19, s7
  s_mov_b64 s[22:23], s[6:7]
  v_and_b32 v125, 15, v0
  v_lshrrev_b32 v126, 4, v124
  s_and_b32 s62, s33, 3
  s_lshr_b32 s63, s33, 2
  s_sub_u32 s64, 3, s62
  s_cmp_ge_u32 s63, 2
  s_cselect_b32 s60, s64, s62
  s_add_u32 s63, s63, 3
  s_and_b32 s63, s63, 3
  s_lshl2_add_u32 s60, s63, s60
  s_lshl_b32 s60, s60, 4
  s_sub_u32 s61, s64, s62
  s_add_u32 s61, s61, 4
  s_lshl_b32 s61, s61, 4
  v_lshlrev_b32 v25, 4, v125
  v_lshlrev_b32 v27, 4, v125
  v_lshlrev_b32 v29, 4, v125
  v_lshlrev_b32 v31, 4, v125
  v_lshl_add_u32 v11, v126, 2, s60
  s_add_u32 s60, s60, 23296
  v_mov_b32 v12, 22272
  s_mov_b32 exec_lo, 0x22221111
  s_mov_b32 exec_hi, 0x88884444
  v_and_or_b32 v12, v0, 12, s60
  s_mov_b64 exec, -1
  s_mov_b32 s64, 0x00100001
  s_mov_b32 s65, 0x10000100
  s_lshl_b64 s[66:67], s[64:65], 1
  s_lshl_b64 s[68:69], s[64:65], 2
  s_lshl_b64 s[70:71], s[64:65], 3
  v_mov_b32 v127, 0x3f80
  v_cndmask_b32 v4, 0, v127, s[64:65]
  v_cndmask_b32 v5, 0, v127, s[66:67]
  v_cndmask_b32 v6, 0, v127, s[68:69]
  v_cndmask_b32 v7, 0, v127, s[70:71]
  s_movk_i32 s63, 5120
  v_lshrrev_b32 v127, 2, v125
  v_mad_u32_u24 v13, v127, s63, v25
  v_lshl_add_u32 v15, v125, 3, s36
  v_add_u32 v14, s35, v15
  s_lshl_b32 s64, s33, 1
  s_sub_u32 s65, 44, s64
  s_sub_u32 s64, 46, s64
  s_cmp_eq_u32 s33, 0
  s_cselect_b32 s64, 96, s64
  s_cmp_eq_u32 s33, 15
  s_cselect_b32 s65, -2, s65
  s_sub_u32 s66, s65, s64
  v_mul_u32_u24 v19, 100, v124
  v_lshl_or_b32 v16, v124, 8, v25
  v_lshl_or_b32 v16, v16, 16, v19
  v_add_u32 v18, s64, v19
  v_add_u32 v19, s65, v19
  v_mul_u32_u24 v20, 100, v125
  v_lshl_or_b32 v17, v125, 8, v25
  v_lshl_or_b32 v17, v17, 16, v20
  v_add_u32 v17, 1073748224, v17
  s_add_u32 s64, s64, 6400
  v_mad_i32_i24 v20, v126, s66, v20
  v_add_u32 v20, s64, v20
  v_lshlrev_b32 v21, 2, v125
  v_lshlrev_b32 v22, 3, v124
  v_mov_b32 v23, 0
  s_mov_b32 s28, 1325400064
  s_mov_b32 s29, 805306368
  s_mov_b32 s26, -16
  s_mov_b32 s27, -65
  s_mov_b32 s37, 73472
  s_cmp_lt_u32 s33, 8
  s_cbranch_scc1 LO1
  v_bfe_u32 v117, v124, 2, 2
  v_bfe_u32 v116, v124, 3, 2
  v_lshl_or_b32 v117, v126, 5, v117
  v_xor_b32 v116, s62, v116
  v_lshl_or_b32 v117, v117, 2, v116
  v_and_b32 v116, 3, v124
  v_lshl_or_b32 v117, v117, 2, v116
  v_lshlrev_b32 v117, 3, v117
  v_lshlrev_b32 v3, 1, v124
  v_lshlrev_b32 v2, 4, v124
  v_and_b32 v3, 0x20, v3
  v_and_b32 v2, 0x70, v2
  s_mul_i32 s38, s62, 2112
  v_xor_b32 v3, v3, v2
  v_lshrrev_b32 v2, 3, v124
  s_and_b32 s38, s38, 6208
  s_lshl_b32 s39, s30, 7
  v_lshl_or_b32 v2, v2, 8, v3
  s_or_b32 s38, s38, s39
  v_xor_b32 v2, s38, v2
  s_movk_i32 s40, 7168
  s_movk_i32 s41, 14336
  s_movk_i32 s42, 21504
  v_and_b32 v116, 3, v0
  v_lshl_or_b32 v116, v116, 2, v127
  v_and_b32 v1, 48, v0
  v_xor_b32 v118, v116, v126
  v_lshl_or_b32 v1, v116, 15, v1
  v_lshlrev_b32 v118, 4, v118
  v_lshl_or_b32 v112, v116, 8, v118
  v_xor_b32 v113, 64, v112
  v_xor_b32 v114, 0x80, v112
  v_xor_b32 v115, 0xc0, v112
  v_mov_b32 v3, 1
  s_lshl_b32 s43, s62, 12
  s_mul_i32 s63, s62, 5184
  s_cmp_ge_u32 s33, 12
  s_cbranch_scc1 PID
  s_setprio 1
  s_mul_i32 s64, s30, 2621440
  s_add_u32 s64, s64, 3145728
  s_add_u32 s64, s24, s64
  s_addc_u32 s65, s25, 0
  s_mov_b64 s[66:67], s[6:7]
  s_mov_b32 s56, 3216550459
  s_mov_b32 s57, 0x07060100
  s_mov_b32 s58, 0x07060302
  s_lshl2_add_u32 s59, s31, s62
  s_lshl_b32 s59, s59, 6
  s_add_u32 s38, s35, 10112*256
  s_cmp_lg_u32 s62, 0
  s_cbranch_scc1 GDM
  v_mov_b32 v119, 0x7149
  v_lshl_add_u32 v116, v124, 2, s38
  global_store_dword v116, v119, s[14:15] sc1
GDM:
  v_mov_b32 v116, 3216550459
  s_lshl_b32 s38, s30, 10
  s_add_u32 s38, s38, s31
  s_lshl_b32 s38, s38, 3
  s_add_u32 s38, s38, 32768
  v_lshl_add_u32 v119, v124, 10, s38
  s_mov_b32 s39, 0x200000
GS0:
  ds_read_b32 v120, v23 offset:22848
  s_sub_u32 s39, s39, 1
  s_cbranch_scc1 GS0X
  s_waitcnt lgkmcnt(0)
  v_cmp_ne_u32 vcc, 4, v120
  s_cbranch_vccnz GS0
GS0X:
  ds_read_b64_tr_b16 v[32:33], v117 offset:25600
  ds_read_b64_tr_b16 v[34:35], v117 offset:26112
  ds_read_b64_tr_b16 v[36:37], v117 offset:26624
  ds_read_b64_tr_b16 v[38:39], v117 offset:27136
  ds_read_b64_tr_b16 v[40:41], v117 offset:27648
  ds_read_b64_tr_b16 v[42:43], v117 offset:28160
  ds_read_b64_tr_b16 v[44:45], v117 offset:28672
  ds_read_b64_tr_b16 v[46:47], v117 offset:29184
  ds_read_b64_tr_b16 v[48:49], v117 offset:41984
  ds_read_b64_tr_b16 v[50:51], v117 offset:42496
  ds_read_b64_tr_b16 v[52:53], v117 offset:43008
  ds_read_b64_tr_b16 v[54:55], v117 offset:43520
  ds_read_b64_tr_b16 v[56:57], v117 offset:44032
  ds_read_b64_tr_b16 v[58:59], v117 offset:44544
  ds_read_b64_tr_b16 v[60:61], v117 offset:45056
  ds_read_b64_tr_b16 v[62:63], v117 offset:45568
  v_add_u32 v117, 117504, v117
  s_mov_b32 s39, 0x200000
  ds_read_b32 v120, v23 offset:22852
  ds_read_b128 v[64:67], v112 offset:0
  ds_read_b128 v[68:71], v113 offset:0
  ds_read_b128 v[72:75], v114 offset:0
  ds_read_b128 v[76:79], v115 offset:0
  s_add_u32 m0, s43, 117504
  s_mov_b64 s[68:69], s[48:49]
  s_mov_b32 s70, 32768
  s_mov_b32 s71, s7
  buffer_load_dwordx4 v2, s[68:71], 0 offen offset:0  lds
  buffer_load_dwordx4 v2, s[68:71], s40 offen offset:1024  lds
  buffer_load_dwordx4 v2, s[68:71], s41 offen offset:2048  lds
  buffer_load_dwordx4 v2, s[68:71], s42 offen offset:3072  lds
XB0:
  s_waitcnt lgkmcnt(0)
  v_cmp_ne_u32 vcc, 4, v120
  s_cbranch_vccnz XR0
XC0:
  v_mfma_f32_16x16x32_bf16 v[96:99], v[32:35], v[64:67], 0
  ds_read_b32 v120, v23 offset:22856
  ds_read_b128 v[80:83], v112 offset:4096
  ds_read_b128 v[84:87], v113 offset:4096
  ds_read_b128 v[88:91], v114 offset:4096
  ds_read_b128 v[92:95], v115 offset:4096
  v_mfma_f32_16x16x32_bf16 v[100:103], v[48:51], v[64:67], 0
  v_mfma_f32_16x16x32_bf16 v[96:99], v[36:39], v[68:71], v[96:99]
  v_mfma_f32_16x16x32_bf16 v[100:103], v[52:55], v[68:71], v[100:103]
  v_mfma_f32_16x16x32_bf16 v[96:99], v[40:43], v[72:75], v[96:99]
  v_mfma_f32_16x16x32_bf16 v[100:103], v[56:59], v[72:75], v[100:103]
  v_mfma_f32_16x16x32_bf16 v[96:99], v[44:47], v[76:79], v[96:99]
  v_mfma_f32_16x16x32_bf16 v[100:103], v[60:63], v[76:79], v[100:103]
XB1:
  s_waitcnt lgkmcnt(0)
  v_cmp_ne_u32 vcc, 4, v120
  s_cbranch_vccnz XR1
XC1:
  v_mfma_f32_16x16x32_bf16 v[104:107], v[32:35], v[80:83], 0
  ds_read_b32 v120, v23 offset:22860
  ds_read_b128 v[64:67], v112 offset:8192
  ds_read_b128 v[68:71], v113 offset:8192
  ds_read_b128 v[72:75], v114 offset:8192
  ds_read_b128 v[76:79], v115 offset:8192
  v_mfma_f32_16x16x32_bf16 v[108:111], v[48:51], v[80:83], 0
  v_mul_f32 v96, s56, v96
  v_mfma_f32_16x16x32_bf16 v[104:107], v[36:39], v[84:87], v[104:107]
  v_mul_f32 v97, s56, v97
  v_mul_f32 v98, s56, v98
  v_mfma_f32_16x16x32_bf16 v[108:111], v[52:55], v[84:87], v[108:111]
  v_mul_f32 v99, s56, v99
  v_cvt_pk_bf16_f32 v96, v96, v97
  v_mfma_f32_16x16x32_bf16 v[104:107], v[40:43], v[88:91], v[104:107]
  v_cvt_pk_bf16_f32 v98, v98, v99
  v_mfma_f32_16x16x32_bf16 v[108:111], v[56:59], v[88:91], v[108:111]
  v_perm_b32 v100, v100, v96, s57
  v_perm_b32 v101, v101, v96, s58
  v_mfma_f32_16x16x32_bf16 v[104:107], v[44:47], v[92:95], v[104:107]
  v_perm_b32 v102, v102, v98, s57
  v_perm_b32 v103, v103, v98, s58
  v_mfma_f32_16x16x32_bf16 v[108:111], v[60:63], v[92:95], v[108:111]
  buffer_store_dwordx4 v[100:103], v1, s[64:67], s59 offen offset:0 sc1
  s_add_u32 s59, s59, 524288
XB2:
  s_waitcnt lgkmcnt(0)
  v_cmp_ne_u32 vcc, 4, v120
  s_cbranch_vccnz XR2
XC2:
  v_mfma_f32_16x16x32_bf16 v[96:99], v[32:35], v[64:67], 0
  ds_read_b32 v120, v23 offset:22864
  ds_read_b128 v[80:83], v112 offset:12288
  ds_read_b128 v[84:87], v113 offset:12288
  ds_read_b128 v[88:91], v114 offset:12288
  ds_read_b128 v[92:95], v115 offset:12288
  v_mfma_f32_16x16x32_bf16 v[100:103], v[48:51], v[64:67], 0
  v_mul_f32 v104, s56, v104
  v_mfma_f32_16x16x32_bf16 v[96:99], v[36:39], v[68:71], v[96:99]
  v_mul_f32 v105, s56, v105
  v_mul_f32 v106, s56, v106
  v_mfma_f32_16x16x32_bf16 v[100:103], v[52:55], v[68:71], v[100:103]
  v_mul_f32 v107, s56, v107
  v_cvt_pk_bf16_f32 v104, v104, v105
  v_mfma_f32_16x16x32_bf16 v[96:99], v[40:43], v[72:75], v[96:99]
  v_cvt_pk_bf16_f32 v106, v106, v107
  v_mfma_f32_16x16x32_bf16 v[100:103], v[56:59], v[72:75], v[100:103]
  v_perm_b32 v108, v108, v104, s57
  v_perm_b32 v109, v109, v104, s58
  v_mfma_f32_16x16x32_bf16 v[96:99], v[44:47], v[76:79], v[96:99]
  v_perm_b32 v110, v110, v106, s57
  v_perm_b32 v111, v111, v106, s58
  v_mfma_f32_16x16x32_bf16 v[100:103], v[60:63], v[76:79], v[100:103]
  buffer_store_dwordx4 v[108:111], v1, s[64:67], s59 offen offset:0 sc1
  s_add_u32 s59, s59, 524288
XB3:
  s_waitcnt lgkmcnt(0)
  v_cmp_ne_u32 vcc, 4, v120
  s_cbranch_vccnz XR3
XC3:
  v_mfma_f32_16x16x32_bf16 v[104:107], v[32:35], v[80:83], 0
  ds_read_b32 v120, v23 offset:22868
  ds_read_b128 v[64:67], v112 offset:16384
  ds_read_b128 v[68:71], v113 offset:16384
  ds_read_b128 v[72:75], v114 offset:16384
  ds_read_b128 v[76:79], v115 offset:16384
  v_mfma_f32_16x16x32_bf16 v[108:111], v[48:51], v[80:83], 0
  v_mul_f32 v96, s56, v96
  v_mfma_f32_16x16x32_bf16 v[104:107], v[36:39], v[84:87], v[104:107]
  v_mul_f32 v97, s56, v97
  v_mul_f32 v98, s56, v98
  v_mfma_f32_16x16x32_bf16 v[108:111], v[52:55], v[84:87], v[108:111]
  v_mul_f32 v99, s56, v99
  v_cvt_pk_bf16_f32 v96, v96, v97
  v_mfma_f32_16x16x32_bf16 v[104:107], v[40:43], v[88:91], v[104:107]
  v_cvt_pk_bf16_f32 v98, v98, v99
  v_mfma_f32_16x16x32_bf16 v[108:111], v[56:59], v[88:91], v[108:111]
  v_perm_b32 v100, v100, v96, s57
  v_perm_b32 v101, v101, v96, s58
  v_mfma_f32_16x16x32_bf16 v[104:107], v[44:47], v[92:95], v[104:107]
  v_perm_b32 v102, v102, v98, s57
  v_perm_b32 v103, v103, v98, s58
  v_mfma_f32_16x16x32_bf16 v[108:111], v[60:63], v[92:95], v[108:111]
  buffer_store_dwordx4 v[100:103], v1, s[64:67], s59 offen offset:0 sc1
  s_add_u32 s59, s59, 524288
XB4:
  s_waitcnt lgkmcnt(0)
  v_cmp_ne_u32 vcc, 4, v120
  s_cbranch_vccnz XR4
XC4:
  v_mfma_f32_16x16x32_bf16 v[96:99], v[32:35], v[64:67], 0
  v_mfma_f32_16x16x32_bf16 v[100:103], v[48:51], v[64:67], 0
  v_mul_f32 v104, s56, v104
  v_mfma_f32_16x16x32_bf16 v[96:99], v[36:39], v[68:71], v[96:99]
  v_mul_f32 v105, s56, v105
  v_mul_f32 v106, s56, v106
  v_mfma_f32_16x16x32_bf16 v[100:103], v[52:55], v[68:71], v[100:103]
  v_mul_f32 v107, s56, v107
  v_cvt_pk_bf16_f32 v104, v104, v105
  v_mfma_f32_16x16x32_bf16 v[96:99], v[40:43], v[72:75], v[96:99]
  v_cvt_pk_bf16_f32 v106, v106, v107
  v_mfma_f32_16x16x32_bf16 v[100:103], v[56:59], v[72:75], v[100:103]
  v_perm_b32 v108, v108, v104, s57
  v_perm_b32 v109, v109, v104, s58
  v_mfma_f32_16x16x32_bf16 v[96:99], v[44:47], v[76:79], v[96:99]
  v_perm_b32 v110, v110, v106, s57
  v_perm_b32 v111, v111, v106, s58
  v_mfma_f32_16x16x32_bf16 v[100:103], v[60:63], v[76:79], v[100:103]
  buffer_store_dwordx4 v[108:111], v1, s[64:67], s59 offen offset:0 sc1
  s_add_u32 s59, s59, 524288
  s_nop 3
  v_mul_f32 v96, s56, v96
  v_mul_f32 v97, s56, v97
  v_mul_f32 v98, s56, v98
  v_mul_f32 v99, s56, v99
  v_cvt_pk_bf16_f32 v96, v96, v97
  v_cvt_pk_bf16_f32 v98, v98, v99
  v_perm_b32 v100, v100, v96, s57
  v_perm_b32 v101, v101, v96, s58
  v_perm_b32 v102, v102, v98, s57
  v_perm_b32 v103, v103, v98, s58
  buffer_store_dwordx4 v[100:103], v1, s[64:67], s59 offen offset:0 sc1
  s_branch GW
XR0:
  ds_read_b32 v120, v23 offset:22852
  ds_read_b128 v[64:67], v112 offset:0
  ds_read_b128 v[68:71], v113 offset:0
  ds_read_b128 v[72:75], v114 offset:0
  ds_read_b128 v[76:79], v115 offset:0
  s_sub_u32 s39, s39, 1
  s_cbranch_scc0 XB0
  s_waitcnt lgkmcnt(0)
  s_branch XC0
XR1:
  ds_read_b32 v120, v23 offset:22856
  ds_read_b128 v[80:83], v112 offset:4096
  ds_read_b128 v[84:87], v113 offset:4096
  ds_read_b128 v[88:91], v114 offset:4096
  ds_read_b128 v[92:95], v115 offset:4096
  s_sub_u32 s39, s39, 1
  s_cbranch_scc0 XB1
  s_waitcnt lgkmcnt(0)
  s_branch XC1
XR2:
  ds_read_b32 v120, v23 offset:22860
  ds_read_b128 v[64:67], v112 offset:8192
  ds_read_b128 v[68:71], v113 offset:8192
  ds_read_b128 v[72:75], v114 offset:8192
  ds_read_b128 v[76:79], v115 offset:8192
  s_sub_u32 s39, s39, 1
  s_cbranch_scc0 XB2
  s_waitcnt lgkmcnt(0)
  s_branch XC2
XR3:
  ds_read_b32 v120, v23 offset:22864
  ds_read_b128 v[80:83], v112 offset:12288
  ds_read_b128 v[84:87], v113 offset:12288
  ds_read_b128 v[88:91], v114 offset:12288
  ds_read_b128 v[92:95], v115 offset:12288
  s_sub_u32 s39, s39, 1
  s_cbranch_scc0 XB3
  s_waitcnt lgkmcnt(0)
  s_branch XC3
XR4:
  ds_read_b32 v120, v23 offset:22868
  ds_read_b128 v[64:67], v112 offset:16384
  ds_read_b128 v[68:71], v113 offset:16384
  ds_read_b128 v[72:75], v114 offset:16384
  ds_read_b128 v[76:79], v115 offset:16384
  s_sub_u32 s39, s39, 1
  s_cbranch_scc0 XB4
  s_waitcnt lgkmcnt(0)
  s_branch XC4
GW:
  s_waitcnt vmcnt(5)
  s_add_u32 m0, s63, 23808
  s_barrier
  ds_read_b64 v[122:123], v23 offset:22928
  ds_read_b64 v[8:9], v22 offset:20480
  s_setprio 0
  ds_read_b64_tr_b16 v[32:33], v117 offset:0
  ds_read_b64_tr_b16 v[34:35], v117 offset:512
  ds_read_b64_tr_b16 v[36:37], v117 offset:1024
  ds_read_b64_tr_b16 v[38:39], v117 offset:1536
  ds_read_b64_tr_b16 v[40:41], v117 offset:2048
  ds_read_b64_tr_b16 v[42:43], v117 offset:2560
  ds_read_b64_tr_b16 v[44:45], v117 offset:3072
  ds_read_b64_tr_b16 v[46:47], v117 offset:3584
  ds_read_b128 v[48:51], v112 offset:0
  ds_read_b128 v[52:55], v113 offset:0
  ds_read_b128 v[56:59], v114 offset:0
  ds_read_b128 v[60:63], v115 offset:0
  ds_read_b128 v[64:67], v112 offset:4096
  ds_read_b128 v[68:71], v113 offset:4096
  ds_read_b128 v[72:75], v114 offset:4096
  ds_read_b128 v[76:79], v115 offset:4096
  ds_read_b128 v[80:83], v112 offset:8192
  ds_read_b128 v[84:87], v113 offset:8192
  ds_read_b128 v[88:91], v114 offset:8192
  ds_read_b128 v[92:95], v115 offset:8192
  s_waitcnt lgkmcnt(4)
  v_mfma_f32_16x16x32_bf16 v[96:99], v[48:51], v[32:35], 0
  v_mfma_f32_16x16x32_bf16 v[100:103], v[64:67], v[32:35], 0
  v_mfma_f32_16x16x32_bf16 v[96:99], v[52:55], v[36:39], v[96:99]
  v_mfma_f32_16x16x32_bf16 v[100:103], v[68:71], v[36:39], v[100:103]
  v_mfma_f32_16x16x32_bf16 v[96:99], v[56:59], v[40:43], v[96:99]
  v_mfma_f32_16x16x32_bf16 v[100:103], v[72:75], v[40:43], v[100:103]
  v_mfma_f32_16x16x32_bf16 v[96:99], v[60:63], v[44:47], v[96:99]
  v_mfma_f32_16x16x32_bf16 v[100:103], v[76:79], v[44:47], v[100:103]
  ds_read_b128 v[48:51], v112 offset:12288
  ds_read_b128 v[52:55], v113 offset:12288
  ds_read_b128 v[56:59], v114 offset:12288
  ds_read_b128 v[60:63], v115 offset:12288
  ds_read_b128 v[64:67], v112 offset:16384
  ds_read_b128 v[68:71], v113 offset:16384
  ds_read_b128 v[72:75], v114 offset:16384
  ds_read_b128 v[76:79], v115 offset:16384
  s_waitcnt lgkmcnt(8)
  v_mfma_f32_16x16x32_bf16 v[104:107], v[80:83], v[32:35], 0
  v_fmaak_f32 v96, v116, v96, 3262644224
  v_fmaak_f32 v97, v116, v97, 3262644224
  v_fmaak_f32 v98, v116, v98, 3262644224
  v_fmaak_f32 v99, v116, v99, 3262644224
  v_mfma_f32_16x16x32_bf16 v[104:107], v[84:87], v[36:39], v[104:107]
  ds_write_addtid_b32 v96 offset:0
  ds_write_addtid_b32 v97 offset:256
  ds_write_addtid_b32 v98 offset:512
  ds_write_addtid_b32 v99 offset:768
  v_mfma_f32_16x16x32_bf16 v[104:107], v[88:91], v[40:43], v[104:107]
  v_fmaak_f32 v100, v116, v100, 3262644224
  v_fmaak_f32 v101, v116, v101, 3262644224
  v_fmaak_f32 v102, v116, v102, 3262644224
  v_fmaak_f32 v103, v116, v103, 3262644224
  v_mfma_f32_16x16x32_bf16 v[104:107], v[92:95], v[44:47], v[104:107]
  ds_write_addtid_b32 v100 offset:1024
  ds_write_addtid_b32 v101 offset:1280
  ds_write_addtid_b32 v102 offset:1536
  ds_write_addtid_b32 v103 offset:1792
  s_waitcnt lgkmcnt(8)
  v_mfma_f32_16x16x32_bf16 v[96:99], v[48:51], v[32:35], 0
  v_mfma_f32_16x16x32_bf16 v[100:103], v[64:67], v[32:35], 0
  v_mfma_f32_16x16x32_bf16 v[96:99], v[52:55], v[36:39], v[96:99]
  v_mfma_f32_16x16x32_bf16 v[100:103], v[68:71], v[36:39], v[100:103]
  v_mfma_f32_16x16x32_bf16 v[96:99], v[56:59], v[40:43], v[96:99]
  v_mfma_f32_16x16x32_bf16 v[100:103], v[72:75], v[40:43], v[100:103]
  v_mfma_f32_16x16x32_bf16 v[96:99], v[60:63], v[44:47], v[96:99]
  v_mfma_f32_16x16x32_bf16 v[100:103], v[76:79], v[44:47], v[100:103]
  v_fmaak_f32 v104, v116, v104, 3262644224
  v_fmaak_f32 v105, v116, v105, 3262644224
  v_fmaak_f32 v106, v116, v106, 3262644224
  v_fmaak_f32 v107, v116, v107, 3262644224
  ds_write_addtid_b32 v104 offset:2048
  ds_write_addtid_b32 v105 offset:2304
  ds_write_addtid_b32 v106 offset:2560
  ds_write_addtid_b32 v107 offset:2816
  v_fmaak_f32 v96, v116, v96, 3262644224
  v_fmaak_f32 v97, v116, v97, 3262644224
  v_fmaak_f32 v98, v116, v98, 3262644224
  v_fmaak_f32 v99, v116, v99, 3262644224
  ds_write_addtid_b32 v96 offset:3072
  ds_write_addtid_b32 v97 offset:3328
  ds_write_addtid_b32 v98 offset:3584
  ds_write_addtid_b32 v99 offset:3840
  v_fmaak_f32 v100, v116, v100, 3262644224
  v_fmaak_f32 v101, v116, v101, 3262644224
  v_fmaak_f32 v102, v116, v102, 3262644224
  v_fmaak_f32 v103, v116, v103, 3262644224
  ds_write_addtid_b32 v100 offset:4096
  ds_write_addtid_b32 v101 offset:4352
  ds_write_addtid_b32 v102 offset:4608
  ds_write_addtid_b32 v103 offset:4864
  s_mov_b64 exec, 1
  s_waitcnt vmcnt(0)
  ds_add_rtn_u32 v2, v23, v3 offset:22872
  s_waitcnt lgkmcnt(0)
  v_cmp_eq_u32 vcc, 3, v2
  s_cbranch_vccz GF0
  s_bfm_b64 exec, 8, 0
  global_store_dwordx2 v119, v[122:123], s[24:25] sc1
  s_mov_b64 exec, 1
GF0:
  s_mov_b64 exec, -1
  s_setprio 0
  s_mov_b32 s56, 0
  s_bfm_b64 s[58:59], 16, 16
  s_mov_b32 s44, 2
  s_setprio 2
  s_mov_b32 s43, 3
  s_mov_b32 m0, 0
  s_barrier
  ds_read_addtid_b32 v110 offset:21504
  ds_read_b32 v111, v21 offset:21760
  s_waitcnt lgkmcnt(0)
  s_branch SORT
FPX:
  s_mov_b32 exec_hi, 0
  s_waitcnt vmcnt(0)
FP:
  v_cmp_ne_u64 vcc, v[122:123], v[120:121]
  s_and_b64 exec, exec, vcc
  s_cbranch_scc1 FPR
FP1:
  s_mov_b64 exec, -1
  s_waitcnt lgkmcnt(0)
  s_barrier
PU:
  buffer_load_dwordx4 v2, s[64:67], 0 offen offset:0  lds
  buffer_load_dwordx4 v2, s[64:67], s40 offen offset:1024  lds
  buffer_load_dwordx4 v2, s[64:67], s41 offen offset:2048  lds
  buffer_load_dwordx4 v2, s[64:67], s42 offen offset:3072  lds
  s_mov_b64 exec, 1
  s_waitcnt vmcnt(0)
  ds_add_u32 v23, v3 offset:22884
  s_mov_b64 exec, -1
  s_mov_b32 s39, 0x200000
GS2:
  ds_read_b32 v120, v23 offset:22884
  s_sub_u32 s39, s39, 1
  s_cbranch_scc1 GS2X
  s_waitcnt lgkmcnt(0)
  v_cmp_ne_u32 vcc, 4, v120
  s_cbranch_vccnz GS2
GS2X:
  s_add_u32 m0, s63, 44544
  ds_read_b64_tr_b16 v[32:33], v117 offset:0
  ds_read_b64_tr_b16 v[34:35], v117 offset:512
  ds_read_b64_tr_b16 v[36:37], v117 offset:1024
  ds_read_b64_tr_b16 v[38:39], v117 offset:1536
  ds_read_b64_tr_b16 v[40:41], v117 offset:2048
  ds_read_b64_tr_b16 v[42:43], v117 offset:2560
  ds_read_b64_tr_b16 v[44:45], v117 offset:3072
  ds_read_b64_tr_b16 v[46:47], v117 offset:3584
  ds_read_b128 v[48:51], v112 offset:0
  ds_read_b128 v[52:55], v113 offset:0
  ds_read_b128 v[56:59], v114 offset:0
  ds_read_b128 v[60:63], v115 offset:0
  ds_read_b128 v[64:67], v112 offset:4096
  ds_read_b128 v[68:71], v113 offset:4096
  ds_read_b128 v[72:75], v114 offset:4096
  ds_read_b128 v[76:79], v115 offset:4096
  ds_read_b128 v[80:83], v112 offset:8192
  ds_read_b128 v[84:87], v113 offset:8192
  ds_read_b128 v[88:91], v114 offset:8192
  ds_read_b128 v[92:95], v115 offset:8192
  s_waitcnt lgkmcnt(4)
  v_mfma_f32_16x16x32_bf16 v[96:99], v[48:51], v[32:35], 0
  v_mfma_f32_16x16x32_bf16 v[100:103], v[64:67], v[32:35], 0
  v_mfma_f32_16x16x32_bf16 v[96:99], v[52:55], v[36:39], v[96:99]
  v_mfma_f32_16x16x32_bf16 v[100:103], v[68:71], v[36:39], v[100:103]
  v_mfma_f32_16x16x32_bf16 v[96:99], v[56:59], v[40:43], v[96:99]
  v_mfma_f32_16x16x32_bf16 v[100:103], v[72:75], v[40:43], v[100:103]
  v_mfma_f32_16x16x32_bf16 v[96:99], v[60:63], v[44:47], v[96:99]
  v_mfma_f32_16x16x32_bf16 v[100:103], v[76:79], v[44:47], v[100:103]
  ds_read_b128 v[48:51], v112 offset:12288
  ds_read_b128 v[52:55], v113 offset:12288
  ds_read_b128 v[56:59], v114 offset:12288
  ds_read_b128 v[60:63], v115 offset:12288
  ds_read_b128 v[64:67], v112 offset:16384
  ds_read_b128 v[68:71], v113 offset:16384
  ds_read_b128 v[72:75], v114 offset:16384
  ds_read_b128 v[76:79], v115 offset:16384
  s_waitcnt lgkmcnt(8)
  v_mfma_f32_16x16x32_bf16 v[104:107], v[80:83], v[32:35], 0
  ds_write_addtid_b32 v96 offset:0
  ds_write_addtid_b32 v97 offset:256
  v_mfma_f32_16x16x32_bf16 v[104:107], v[84:87], v[36:39], v[104:107]
  ds_write_addtid_b32 v98 offset:512
  ds_write_addtid_b32 v99 offset:768
  v_mfma_f32_16x16x32_bf16 v[104:107], v[88:91], v[40:43], v[104:107]
  ds_write_addtid_b32 v100 offset:1024
  ds_write_addtid_b32 v101 offset:1280
  v_mfma_f32_16x16x32_bf16 v[104:107], v[92:95], v[44:47], v[104:107]
  ds_write_addtid_b32 v102 offset:1536
  ds_write_addtid_b32 v103 offset:1792
  s_waitcnt lgkmcnt(8)
  v_mfma_f32_16x16x32_bf16 v[96:99], v[48:51], v[32:35], 0
  v_mfma_f32_16x16x32_bf16 v[100:103], v[64:67], v[32:35], 0
  v_mfma_f32_16x16x32_bf16 v[96:99], v[52:55], v[36:39], v[96:99]
  v_mfma_f32_16x16x32_bf16 v[100:103], v[68:71], v[36:39], v[100:103]
  v_mfma_f32_16x16x32_bf16 v[96:99], v[56:59], v[40:43], v[96:99]
  v_mfma_f32_16x16x32_bf16 v[100:103], v[72:75], v[40:43], v[100:103]
  v_mfma_f32_16x16x32_bf16 v[96:99], v[60:63], v[44:47], v[96:99]
  v_mfma_f32_16x16x32_bf16 v[100:103], v[76:79], v[44:47], v[100:103]
  ds_write_addtid_b32 v104 offset:2048
  ds_write_addtid_b32 v105 offset:2304
  ds_write_addtid_b32 v106 offset:2560
  ds_write_addtid_b32 v107 offset:2816
  s_nop 3
  ds_write_addtid_b32 v96 offset:3072
  ds_write_addtid_b32 v97 offset:3328
  ds_write_addtid_b32 v98 offset:3584
  ds_write_addtid_b32 v99 offset:3840
  ds_write_addtid_b32 v100 offset:4096
  ds_write_addtid_b32 v101 offset:4352
  ds_write_addtid_b32 v102 offset:4608
  ds_write_addtid_b32 v103 offset:4864
  s_mov_b64 exec, 1
  ds_add_u32 v23, v3 offset:22880
  s_mov_b64 exec, -1
  s_mov_b32 m0, 0
  s_branch K2JOB
PID:
  s_add_u32 s38, s36, s31
  s_lshr_b32 s38, s38, 4
  s_lshl2_add_u32 s38, s38, s62
  s_lshl_b32 s38, s38, 8
  s_add_u32 s38, s38, 32768
  v_lshl_add_u32 v118, v124, 3, s38
  v_add_u32 v117, 133888, v117
  v_mov_b32 v116, 3216550459
  s_mul_i32 s38, s62, 2560
  s_add_u32 s38, s38, s31
  v_lshrrev_b32 v108, 1, v124
  v_and_b32 v109, 1, v124
  v_lshl_add_u32 v108, v108, 7, s38
  v_lshlrev_b32 v109, 7, v109
  s_mov_b64 s[64:65], s[54:55]
  s_mov_b32 s66, 32768
  s_mov_b32 s67, s7
  s_movk_i32 s39, 400
  s_waitcnt lgkmcnt(0)
  s_barrier
  ds_read_b64 v[122:123], v23 offset:22928
  ds_read_b64 v[8:9], v22 offset:20480
  s_mov_b32 s56, 0
  s_bfm_b64 s[58:59], 16, 16
  s_mov_b32 s44, 2
  s_setprio 2
  s_add_u32 s57, s43, 133888
  s_mov_b32 s43, 3
  s_mov_b32 m0, 0
  s_mov_b32 exec_hi, 0
  s_barrier
  global_load_dwordx2 v[120:121], v118, s[24:25] sc1
  s_mov_b32 exec_hi, -1
  ds_read_addtid_b32 v110 offset:21504
  ds_read_b32 v111, v21 offset:21760
  s_mov_b32 m0, s57
  s_waitcnt lgkmcnt(0)
  s_branch SORT
LO1:
  s_cmp_lg_u32 s33, 5
  s_cbranch_scc1 PREC
  s_waitcnt vmcnt(0)
  v_lshlrev_b32 v40, 16, v40
  v_mul_f32 v40, 3216550459, v40
  v_lshlrev_b32 v41, 16, v41
  v_mul_f32 v41, 3216550459, v41
  v_lshlrev_b32 v42, 16, v42
  v_mul_f32 v42, 3216550459, v42
  v_lshlrev_b32 v43, 16, v43
  v_mul_f32 v43, 3216550459, v43
  v_cvt_pk_bf16_f32 v40, v40, v41
  v_cvt_pk_bf16_f32 v41, v42, v43
  ds_write_b64 v22, v[40:41] offset:20480
PREC:
  v_lshrrev_b32 v58, 5, v124
  s_lshl_b32 s38, s33, 5
  v_lshl_or_b32 v58, v58, 4, v125
  s_lshr_b32 s39, s31, 4
  v_or_b32 v58, s38, v58
  s_lshl_b32 s39, s39, 14
  s_bfe_u32 s38, s31, 196609
  s_lshl3_add_u32 s39, s38, s39
  s_add_u32 s39, s39, 65536
  s_and_b32 s58, s31, 1
  s_mul_i32 s58, s58, 10
  s_add_u32 s59, s58, 10
  v_mul_u32_u24 v60, 10368, v58
  v_and_b32 v61, 1, v58
  v_lshl_add_u32 v59, v58, 6, s39
  v_mad_u32_u24 v107, v61, 10, s58
  v_lshlrev_b32 v61, 9, v61
  v_cmp_gt_u32 vcc, 250, v58
  v_sub_u32 v60, v60, v61
  v_and_b32 v61, 31, v0
  v_mov_b32 v56, 0
  v_lshlrev_b32 v63, 4, v61
  v_not_b32 v61, v61
  v_xor_b32 v62, 31, v61
  v_mov_b32 v106, 2
  s_mov_b64 s[38:39], vcc
  s_add_u32 s8, s24, 524288
  s_addc_u32 s9, s25, 0
  s_mov_b32 s10, 2602368
  s_mov_b32 s11, s7
  s_movk_i32 s57, 400
  s_movk_i32 s60, 8100
  s_cmp_eq_u32 s33, 0
  s_cselect_b32 s56, -1, 0
PRE1:
  s_waitcnt lgkmcnt(0)
  s_barrier
  ds_read_b32 v122, v23 offset:22944
  ds_read_b64 v[8:9], v22 offset:20480
  s_mov_b64 exec, s[38:39]
RP:
  global_load_dwordx2 v[56:57], v59, s[24:25] sc1
  s_sub_u32 s57, s57, 1
  s_cbranch_scc1 RTO
RP0:
  s_waitcnt vmcnt(0) lgkmcnt(0)
  v_cmp_ne_u32 vcc, v122, v57
  s_and_b64 exec, exec, vcc
  s_cbranch_scc1 RP
  s_mov_b64 exec, -1
RP1:
  v_bfe_u32 v96, v56, s59, 10
  v_bfe_u32 v97, v56, s58, 10
  v_bfe_u32 v57, v56, v107, 10
  v_sub_u32 v56, v96, v97
  v_lshl_add_u32 v57, v57, 4, v60
  s_nop 0
  v_add_co_u32_dpp v97, vcc, v56, v62 row_newbcast:1 row_mask:0xf bank_mask:0xf
  v_add_u32_dpp v96, v57, v63 row_newbcast:0 row_mask:0xf bank_mask:0xf
  s_mov_b64 s[40:41], vcc
  v_add_co_u32_dpp v97, vcc, v56, v61 row_newbcast:0 row_mask:0xf bank_mask:0xf
  v_add_u32_dpp v98, v57, v63 row_newbcast:1 row_mask:0xf bank_mask:0xf
  s_or_b64 exec, s[40:41], vcc
  v_cndmask_b32 v98, v98, v96, vcc
  buffer_load_dwordx4 v[64:67], v98, s[8:11], 0 offen sc1
  s_or_saveexec_b64 s[40:41], -1
  v_add_co_u32_dpp v97, vcc, v56, v62 row_newbcast:3 row_mask:0xf bank_mask:0xf
  v_add_u32_dpp v96, v57, v63 row_newbcast:2 row_mask:0xf bank_mask:0xf
  s_mov_b64 s[42:43], vcc
  v_add_co_u32_dpp v97, vcc, v56, v61 row_newbcast:2 row_mask:0xf bank_mask:0xf
  v_add_u32_dpp v99, v57, v63 row_newbcast:3 row_mask:0xf bank_mask:0xf
  s_or_b64 exec, s[42:43], vcc
  v_cndmask_b32 v99, v99, v96, vcc
  buffer_load_dwordx4 v[68:71], v99, s[8:11], 0 offen sc1
  s_or_saveexec_b64 s[42:43], -1
  v_add_co_u32_dpp v97, vcc, v56, v62 row_newbcast:5 row_mask:0xf bank_mask:0xf
  v_add_u32_dpp v96, v57, v63 row_newbcast:4 row_mask:0xf bank_mask:0xf
  s_mov_b64 s[44:45], vcc
  v_add_co_u32_dpp v97, vcc, v56, v61 row_newbcast:4 row_mask:0xf bank_mask:0xf
  v_add_u32_dpp v100, v57, v63 row_newbcast:5 row_mask:0xf bank_mask:0xf
  s_or_b64 exec, s[44:45], vcc
  v_cndmask_b32 v100, v100, v96, vcc
  buffer_load_dwordx4 v[72:75], v100, s[8:11], 0 offen sc1
  s_or_saveexec_b64 s[44:45], -1
  v_add_co_u32_dpp v97, vcc, v56, v62 row_newbcast:7 row_mask:0xf bank_mask:0xf
  v_add_u32_dpp v96, v57, v63 row_newbcast:6 row_mask:0xf bank_mask:0xf
  s_mov_b64 s[46:47], vcc
  v_add_co_u32_dpp v97, vcc, v56, v61 row_newbcast:6 row_mask:0xf bank_mask:0xf
  v_add_u32_dpp v101, v57, v63 row_newbcast:7 row_mask:0xf bank_mask:0xf
  s_or_b64 exec, s[46:47], vcc
  v_cndmask_b32 v101, v101, v96, vcc
  buffer_load_dwordx4 v[76:79], v101, s[8:11], 0 offen sc1
  s_or_saveexec_b64 s[46:47], -1
  v_add_co_u32_dpp v97, vcc, v56, v62 row_newbcast:9 row_mask:0xf bank_mask:0xf
  v_add_u32_dpp v96, v57, v63 row_newbcast:8 row_mask:0xf bank_mask:0xf
  s_mov_b64 s[48:49], vcc
  v_add_co_u32_dpp v97, vcc, v56, v61 row_newbcast:8 row_mask:0xf bank_mask:0xf
  v_add_u32_dpp v102, v57, v63 row_newbcast:9 row_mask:0xf bank_mask:0xf
  s_or_b64 exec, s[48:49], vcc
  v_cndmask_b32 v102, v102, v96, vcc
  buffer_load_dwordx4 v[80:83], v102, s[8:11], 0 offen sc1
  s_or_saveexec_b64 s[48:49], -1
  v_add_co_u32_dpp v97, vcc, v56, v62 row_newbcast:11 row_mask:0xf bank_mask:0xf
  v_add_u32_dpp v96, v57, v63 row_newbcast:10 row_mask:0xf bank_mask:0xf
  s_mov_b64 s[50:51], vcc
  v_add_co_u32_dpp v97, vcc, v56, v61 row_newbcast:10 row_mask:0xf bank_mask:0xf
  v_add_u32_dpp v103, v57, v63 row_newbcast:11 row_mask:0xf bank_mask:0xf
  s_or_b64 exec, s[50:51], vcc
  v_cndmask_b32 v103, v103, v96, vcc
  buffer_load_dwordx4 v[84:87], v103, s[8:11], 0 offen sc1
  s_or_saveexec_b64 s[50:51], -1
  v_add_co_u32_dpp v97, vcc, v56, v62 row_newbcast:13 row_mask:0xf bank_mask:0xf
  v_add_u32_dpp v96, v57, v63 row_newbcast:12 row_mask:0xf bank_mask:0xf
  s_mov_b64 s[52:53], vcc
  v_add_co_u32_dpp v97, vcc, v56, v61 row_newbcast:12 row_mask:0xf bank_mask:0xf
  v_add_u32_dpp v104, v57, v63 row_newbcast:13 row_mask:0xf bank_mask:0xf
  s_or_b64 exec, s[52:53], vcc
  v_cndmask_b32 v104, v104, v96, vcc
  buffer_load_dwordx4 v[88:91], v104, s[8:11], 0 offen sc1
  s_or_saveexec_b64 s[52:53], -1
  v_add_co_u32_dpp v97, vcc, v56, v62 row_newbcast:15 row_mask:0xf bank_mask:0xf
  v_add_u32_dpp v96, v57, v63 row_newbcast:14 row_mask:0xf bank_mask:0xf
  s_mov_b64 s[54:55], vcc
  v_add_co_u32_dpp v97, vcc, v56, v61 row_newbcast:14 row_mask:0xf bank_mask:0xf
  v_add_u32_dpp v105, v57, v63 row_newbcast:15 row_mask:0xf bank_mask:0xf
  s_or_b64 exec, s[54:55], vcc
  v_cndmask_b32 v105, v105, v96, vcc
  buffer_load_dwordx4 v[92:95], v105, s[8:11], 0 offen sc1
  s_or_saveexec_b64 s[54:55], -1
  v_add_u32_dpp v57, v56, v56 quad_perm:[1,0,3,2] row_mask:0xf bank_mask:0xf
  v_cmp_lt_u32 vcc, 32, v57
  s_cbranch_vccnz ROV
ROV1:
  s_mov_b64 exec, s[40:41]
  s_waitcnt vmcnt(7)
RB0:
  v_cmp_ne_u32 vcc, v122, v67
  v_lshrrev_b32 v67, 16, v66
  s_cbranch_vccnz RR0
RC0:
  ds_add_rtn_u32 v67, v67, v106 offset:21504
  s_mov_b64 exec, s[42:43]
  s_waitcnt vmcnt(6)
RB1:
  v_cmp_ne_u32 vcc, v122, v71
  v_lshrrev_b32 v71, 16, v70
  s_cbranch_vccnz RR1
RC1:
  ds_add_rtn_u32 v71, v71, v106 offset:21504
  s_mov_b64 exec, s[40:41]
  s_waitcnt lgkmcnt(1)
  v_min_u32 v67, s60, v67
  v_lshl_add_u32 v98, v67, 2, s37
  ds_write_b16 v67, v66 offset:65280
  ds_write_b64 v98, v[64:65]
  s_mov_b64 exec, s[44:45]
  s_waitcnt vmcnt(5)
RB2:
  v_cmp_ne_u32 vcc, v122, v75
  v_lshrrev_b32 v75, 16, v74
  s_cbranch_vccnz RR2
RC2:
  ds_add_rtn_u32 v75, v75, v106 offset:21504
  s_mov_b64 exec, s[42:43]
  s_waitcnt lgkmcnt(3)
  v_min_u32 v71, s60, v71
  v_lshl_add_u32 v99, v71, 2, s37
  ds_write_b16 v71, v70 offset:65280
  ds_write_b64 v99, v[68:69]
  s_mov_b64 exec, s[46:47]
  s_waitcnt vmcnt(4)
RB3:
  v_cmp_ne_u32 vcc, v122, v79
  v_lshrrev_b32 v79, 16, v78
  s_cbranch_vccnz RR3
RC3:
  ds_add_rtn_u32 v79, v79, v106 offset:21504
  s_mov_b64 exec, s[44:45]
  s_waitcnt lgkmcnt(3)
  v_min_u32 v75, s60, v75
  v_lshl_add_u32 v100, v75, 2, s37
  ds_write_b16 v75, v74 offset:65280
  ds_write_b64 v100, v[72:73]
  s_mov_b64 exec, s[48:49]
  s_waitcnt vmcnt(3)
RB4:
  v_cmp_ne_u32 vcc, v122, v83
  v_lshrrev_b32 v83, 16, v82
  s_cbranch_vccnz RR4
RC4:
  ds_add_rtn_u32 v83, v83, v106 offset:21504
  s_mov_b64 exec, s[46:47]
  s_waitcnt lgkmcnt(3)
  v_min_u32 v79, s60, v79
  v_lshl_add_u32 v101, v79, 2, s37
  ds_write_b16 v79, v78 offset:65280
  ds_write_b64 v101, v[76:77]
  s_mov_b64 exec, s[50:51]
  s_waitcnt vmcnt(2)
RB5:
  v_cmp_ne_u32 vcc, v122, v87
  v_lshrrev_b32 v87, 16, v86
  s_cbranch_vccnz RR5
RC5:
  ds_add_rtn_u32 v87, v87, v106 offset:21504
  s_mov_b64 exec, s[48:49]
  s_waitcnt lgkmcnt(3)
  v_min_u32 v83, s60, v83
  v_lshl_add_u32 v102, v83, 2, s37
  ds_write_b16 v83, v82 offset:65280
  ds_write_b64 v102, v[80:81]
  s_mov_b64 exec, s[52:53]
  s_waitcnt vmcnt(1)
RB6:
  v_cmp_ne_u32 vcc, v122, v91
  v_lshrrev_b32 v91, 16, v90
  s_cbranch_vccnz RR6
RC6:
  ds_add_rtn_u32 v91, v91, v106 offset:21504
  s_mov_b64 exec, s[54:55]
  s_waitcnt vmcnt(0)
RB7:
  v_cmp_ne_u32 vcc, v122, v95
  v_lshrrev_b32 v95, 16, v94
  s_cbranch_vccnz RR7
RC7:
  ds_add_rtn_u32 v95, v95, v106 offset:21504
  s_bfm_b64 s[58:59], 16, 16
  s_cmp_lt_u32 s33, 4
  s_cselect_b32 s44, 0, 2
  s_cselect_b32 s43, 0, 3
  s_setprio 2
  s_cbranch_scc0 K2E
  s_setprio 3
K2E:
  s_mov_b64 exec, -1
  s_mov_b32 m0, 0
  s_waitcnt lgkmcnt(0)
  s_barrier
  ds_read_addtid_b32 v110 offset:21504
  ds_read_b32 v111, v21 offset:21760
  s_mov_b64 exec, s[50:51]
  v_min_u32 v87, s60, v87
  v_lshl_add_u32 v103, v87, 2, s37
  ds_write_b16 v87, v86 offset:65280
  ds_write_b64 v103, v[84:85]
  s_mov_b64 exec, s[52:53]
  v_min_u32 v91, s60, v91
  v_lshl_add_u32 v104, v91, 2, s37
  ds_write_b16 v91, v90 offset:65280
  ds_write_b64 v104, v[88:89]
  s_mov_b64 exec, s[54:55]
  v_min_u32 v95, s60, v95
  v_lshl_add_u32 v105, v95, 2, s37
  ds_write_b16 v95, v94 offset:65280
  ds_write_b64 v105, v[92:93]
  s_mov_b64 exec, -1
  s_waitcnt lgkmcnt(6)
SORT:
  v_cmp_gt_i32 s[50:51], v110, v18
  v_cmp_gt_i32 s[54:55], v111, v20
  v_cmp_gt_i32 s[52:53], v110, v19
  v_sub_u32_sdwa v110, v110, v16 dst_sel:DWORD dst_unused:UNUSED_PAD src0_sel:DWORD src1_sel:WORD_0
  v_sub_u32_sdwa v111, v111, v17 dst_sel:DWORD dst_unused:UNUSED_PAD src0_sel:DWORD src1_sel:WORD_0
  s_bcnt1_i32_b64 s46, s[50:51]
  s_lshl_b32 s55, s54, 16
  s_bcnt1_i32_b32 s47, s55
  s_andn2_b32 s54, s54, s55
  s_andn2_b64 s[50:51], s[52:53], s[50:51]
  s_add_u32 s46, s46, s47
  s_bcnt1_i32_b64 s48, s[52:53]
  v_mbcnt_lo_u32_b32 v64, s50, 0
  v_mbcnt_lo_u32_b32 v65, s54, 0
  v_mbcnt_hi_u32_b32 v64, s51, v64
  v_add_lshl_u32 v65, v65, s48, 2
  v_add_lshl_u32 v64, v64, s46, 2
  v_and_b32 v67, -16, v65
  v_and_b32 v66, -16, v64
  s_mov_b64 exec, s[50:51]
  ds_write_b32 v64, v16 offset:23296
  ds_max_u32 v66, v110 offset:22528
  s_and_b64 exec, s[54:55], s[58:59]
  ds_write_b32 v65, v17 offset:23296
  ds_max_u32 v67, v111 offset:22528
  s_mov_b64 exec, -1
  s_and_b32 s46, s46, s56
  s_cbranch_scc1 SOV
SOV1:
  s_cmp_ge_u32 s33, 12
  s_cbranch_scc1 FPX
  s_waitcnt lgkmcnt(0)
  s_barrier
K2JOB:
  ds_read_b32 v124, v11 offset:22528
  ds_read_u16 v125, v11 offset:23296
  ds_read_u16 v126, v12
  ds_read_u8 v127, v11 offset:23299
  ds_read_u16 v10, v11 offset:23298
  ds_read_b128 v[32:35], v25 offset:22016
  ds_read_b128 v[36:39], v25 offset:23040
  s_waitcnt lgkmcnt(6)
  v_readfirstlane_b32 s46, v124
  s_max_u32 s46, s46, 2
  s_sub_u32 s46, s46, 2
  s_cmp_gt_u32 s46, 94
  s_nop 0
  s_cbranch_scc1 K2SLOW
  s_and_b32 s47, s46, -8
  s_lshl2_add_u32 s45, s47, s37
  s_sub_u32 s45, s45, 128
  s_waitcnt lgkmcnt(2)
  v_add_u32 v0, s47, v125
  v_lshl_add_u32 v1, v126, 2, s45
  ds_read_u16 v24, v0 offset:65280
  ds_read_u16 v26, v0 offset:65282
  ds_read_u16 v28, v0 offset:65284
  ds_read_u16 v30, v0 offset:65286
  v_lshl_add_u32 v2, v127, 6, v13
  ds_read_b128 v[16:19], v1 offset:128
  ds_read_b128 v[20:23], v1 offset:144
  ds_read_b128 v[40:43], v2 offset:23808
  v_lshl_add_u32 v3, v127, 15, v14
  v_xor_b32_e64 v10, v10, v15
  s_lshr_b32 s47, s46, 3
  s_bitcmp1_b32 s46, 2
  s_cbranch_scc1 K2F34
  s_bitcmp1_b32 s46, 1
  s_cbranch_scc1 K2F2
  s_waitcnt lgkmcnt(3)
  buffer_load_dwordx4 v[56:59], v[24:25], s[16:19], 0 idxen offen sc1
  ds_read_u16 v24, v0 offset:65272
  ds_read_u16 v26, v0 offset:65274
  ds_read_u16 v28, v0 offset:65276
  ds_read_u16 v30, v0 offset:65278
  s_waitcnt lgkmcnt(4)
  v_mfma_f32_16x16x16_bf16 v[88:91], v[16:17], v[8:9], v[40:43]
  ds_read_b128 v[16:19], v1 offset:96
  ds_read_b128 v[20:23], v1 offset:112
  s_waitcnt lgkmcnt(2)
  buffer_load_dwordx4 v[72:75], v[24:25], s[16:19], 0 idxen offen sc1
  buffer_load_dwordx4 v[76:79], v[26:27], s[16:19], 0 idxen offen sc1
  buffer_load_dwordx4 v[80:83], v[28:29], s[16:19], 0 idxen offen sc1
  buffer_load_dwordx4 v[84:87], v[30:31], s[16:19], 0 idxen offen sc1
  ds_read_u16 v24, v0 offset:65264
  ds_read_u16 v26, v0 offset:65266
  ds_read_u16 v28, v0 offset:65268
  ds_read_u16 v30, v0 offset:65270
  s_nop 0
  s_waitcnt lgkmcnt(4)
  v_mfma_f32_16x16x16_bf16 v[104:107], v[16:17], v[8:9], v[40:43]
  v_mfma_f32_16x16x16_bf16 v[108:111], v[18:19], v[8:9], v[40:43]
  v_mfma_f32_16x16x16_bf16 v[112:115], v[20:21], v[8:9], v[40:43]
  v_mfma_f32_16x16x16_bf16 v[116:119], v[22:23], v[8:9], v[40:43]
  ds_read_b128 v[16:19], v1 offset:64
  ds_read_b128 v[20:23], v1 offset:80
  s_waitcnt vmcnt(4)
  v_mfma_f32_16x16x32_bf16 v[88:91], v[4:7], v[56:59], v[88:91]
  s_nop 7
  v_exp_f32 v88, v88 clamp
  v_exp_f32 v89, v89 clamp
  v_exp_f32 v90, v90 clamp
  v_exp_f32 v91, v91 clamp
  s_nop 0
  s_nop 0
  v_pk_fma_f32 v[44:45], v[88:89], s[28:29], s[28:29] op_sel:[0,0,1] op_sel_hi:[1,0,1]
  v_pk_fma_f32 v[46:47], v[90:91], s[28:29], s[28:29] op_sel:[0,0,1] op_sel_hi:[1,0,1]
  v_pk_mov_b32 v[48:49], 1.0, 1.0
  v_pk_mov_b32 v[52:53], v[56:57], v[56:57] op_sel:[0,1]
  v_pk_mov_b32 v[50:51], 1.0, 1.0
  v_pk_mov_b32 v[54:55], v[58:59], v[58:59] op_sel:[0,1]
  s_branch K2F
K2F2:
  s_waitcnt lgkmcnt(3)
  buffer_load_dwordx4 v[56:59], v[24:25], s[16:19], 0 idxen offen sc1
  buffer_load_dwordx4 v[60:63], v[26:27], s[16:19], 0 idxen offen sc1
  ds_read_u16 v24, v0 offset:65272
  ds_read_u16 v26, v0 offset:65274
  ds_read_u16 v28, v0 offset:65276
  ds_read_u16 v30, v0 offset:65278
  s_waitcnt lgkmcnt(4)
  v_mfma_f32_16x16x16_bf16 v[88:91], v[16:17], v[8:9], v[40:43]
  v_mfma_f32_16x16x16_bf16 v[92:95], v[18:19], v[8:9], v[40:43]
  ds_read_b128 v[16:19], v1 offset:96
  ds_read_b128 v[20:23], v1 offset:112
  s_waitcnt lgkmcnt(2)
  buffer_load_dwordx4 v[72:75], v[24:25], s[16:19], 0 idxen offen sc1
  buffer_load_dwordx4 v[76:79], v[26:27], s[16:19], 0 idxen offen sc1
  buffer_load_dwordx4 v[80:83], v[28:29], s[16:19], 0 idxen offen sc1
  buffer_load_dwordx4 v[84:87], v[30:31], s[16:19], 0 idxen offen sc1
  ds_read_u16 v24, v0 offset:65264
  ds_read_u16 v26, v0 offset:65266
  ds_read_u16 v28, v0 offset:65268
  ds_read_u16 v30, v0 offset:65270
  s_nop 0
  s_waitcnt lgkmcnt(4)
  v_mfma_f32_16x16x16_bf16 v[104:107], v[16:17], v[8:9], v[40:43]
  v_mfma_f32_16x16x16_bf16 v[108:111], v[18:19], v[8:9], v[40:43]
  v_mfma_f32_16x16x16_bf16 v[112:115], v[20:21], v[8:9], v[40:43]
  v_mfma_f32_16x16x16_bf16 v[116:119], v[22:23], v[8:9], v[40:43]
  ds_read_b128 v[16:19], v1 offset:64
  ds_read_b128 v[20:23], v1 offset:80
  s_waitcnt vmcnt(4)
  v_mfma_f32_16x16x32_bf16 v[88:91], v[4:7], v[56:59], v[88:91]
  v_mfma_f32_16x16x32_bf16 v[92:95], v[4:7], v[60:63], v[92:95]
  s_nop 6
  v_exp_f32 v88, v88 clamp
  v_exp_f32 v89, v89 clamp
  v_exp_f32 v90, v90 clamp
  v_exp_f32 v91, v91 clamp
  v_exp_f32 v92, v92 clamp
  v_exp_f32 v93, v93 clamp
  v_exp_f32 v94, v94 clamp
  v_exp_f32 v95, v95 clamp
  v_pk_fma_f32 v[88:89], v[88:89], s[28:29], s[28:29] op_sel:[0,0,1] op_sel_hi:[1,0,1]
  v_pk_fma_f32 v[90:91], v[90:91], s[28:29], s[28:29] op_sel:[0,0,1] op_sel_hi:[1,0,1]
  v_pk_fma_f32 v[92:93], v[92:93], s[28:29], s[28:29] op_sel:[0,0,1] op_sel_hi:[1,0,1]
  v_pk_fma_f32 v[94:95], v[94:95], s[28:29], s[28:29] op_sel:[0,0,1] op_sel_hi:[1,0,1]
  v_pk_mul_f32 v[52:53], v[56:57], v[92:93]
  v_pk_mul_f32 v[54:55], v[58:59], v[94:95]
  v_pk_add_f32 v[48:49], v[88:89], v[92:93]
  v_pk_add_f32 v[50:51], v[90:91], v[94:95]
  v_pk_fma_f32 v[52:53], v[60:61], v[88:89], v[52:53]
  v_pk_fma_f32 v[54:55], v[62:63], v[90:91], v[54:55]
  v_pk_mul_f32 v[44:45], v[88:89], v[92:93]
  v_pk_mul_f32 v[46:47], v[90:91], v[94:95]
  s_branch K2F
K2F34:
  s_bitcmp1_b32 s46, 1
  s_cbranch_scc1 K2F4
  s_waitcnt lgkmcnt(3)
  buffer_load_dwordx4 v[56:59], v[24:25], s[16:19], 0 idxen offen sc1
  buffer_load_dwordx4 v[60:63], v[26:27], s[16:19], 0 idxen offen sc1
  buffer_load_dwordx4 v[64:67], v[28:29], s[16:19], 0 idxen offen sc1
  ds_read_u16 v24, v0 offset:65272
  ds_read_u16 v26, v0 offset:65274
  ds_read_u16 v28, v0 offset:65276
  ds_read_u16 v30, v0 offset:65278
  s_nop 0
  s_waitcnt lgkmcnt(4)
  v_mfma_f32_16x16x16_bf16 v[88:91], v[16:17], v[8:9], v[40:43]
  v_mfma_f32_16x16x16_bf16 v[92:95], v[18:19], v[8:9], v[40:43]
  v_mfma_f32_16x16x16_bf16 v[96:99], v[20:21], v[8:9], v[40:43]
  ds_read_b128 v[16:19], v1 offset:96
  ds_read_b128 v[20:23], v1 offset:112
  s_nop 0
  s_waitcnt lgkmcnt(2)
  buffer_load_dwordx4 v[72:75], v[24:25], s[16:19], 0 idxen offen sc1
  buffer_load_dwordx4 v[76:79], v[26:27], s[16:19], 0 idxen offen sc1
  buffer_load_dwordx4 v[80:83], v[28:29], s[16:19], 0 idxen offen sc1
  buffer_load_dwordx4 v[84:87], v[30:31], s[16:19], 0 idxen offen sc1
  ds_read_u16 v24, v0 offset:65264
  ds_read_u16 v26, v0 offset:65266
  ds_read_u16 v28, v0 offset:65268
  ds_read_u16 v30, v0 offset:65270
  s_nop 0
  s_waitcnt lgkmcnt(4)
  v_mfma_f32_16x16x16_bf16 v[104:107], v[16:17], v[8:9], v[40:43]
  v_mfma_f32_16x16x16_bf16 v[108:111], v[18:19], v[8:9], v[40:43]
  v_mfma_f32_16x16x16_bf16 v[112:115], v[20:21], v[8:9], v[40:43]
  v_mfma_f32_16x16x16_bf16 v[116:119], v[22:23], v[8:9], v[40:43]
  ds_read_b128 v[16:19], v1 offset:64
  ds_read_b128 v[20:23], v1 offset:80
  s_waitcnt vmcnt(4)
  v_mfma_f32_16x16x32_bf16 v[88:91], v[4:7], v[56:59], v[88:91]
  v_mfma_f32_16x16x32_bf16 v[92:95], v[4:7], v[60:63], v[92:95]
  v_mfma_f32_16x16x32_bf16 v[96:99], v[4:7], v[64:67], v[96:99]
  s_nop 5
  v_exp_f32 v88, v88 clamp
  v_exp_f32 v89, v89 clamp
  v_exp_f32 v90, v90 clamp
  v_exp_f32 v91, v91 clamp
  v_exp_f32 v92, v92 clamp
  v_exp_f32 v93, v93 clamp
  v_exp_f32 v94, v94 clamp
  v_exp_f32 v95, v95 clamp
  v_exp_f32 v96, v96 clamp
  v_exp_f32 v97, v97 clamp
  v_exp_f32 v98, v98 clamp
  v_exp_f32 v99, v99 clamp
  v_pk_fma_f32 v[88:89], v[88:89], s[28:29], s[28:29] op_sel:[0,0,1] op_sel_hi:[1,0,1]
  v_pk_fma_f32 v[90:91], v[90:91], s[28:29], s[28:29] op_sel:[0,0,1] op_sel_hi:[1,0,1]
  v_pk_fma_f32 v[92:93], v[92:93], s[28:29], s[28:29] op_sel:[0,0,1] op_sel_hi:[1,0,1]
  v_pk_fma_f32 v[94:95], v[94:95], s[28:29], s[28:29] op_sel:[0,0,1] op_sel_hi:[1,0,1]
  v_pk_fma_f32 v[96:97], v[96:97], s[28:29], s[28:29] op_sel:[0,0,1] op_sel_hi:[1,0,1]
  v_pk_fma_f32 v[98:99], v[98:99], s[28:29], s[28:29] op_sel:[0,0,1] op_sel_hi:[1,0,1]
  v_pk_mul_f32 v[52:53], v[56:57], v[92:93]
  v_pk_mul_f32 v[54:55], v[58:59], v[94:95]
  v_pk_add_f32 v[48:49], v[88:89], v[92:93]
  v_pk_add_f32 v[50:51], v[90:91], v[94:95]
  v_pk_fma_f32 v[52:53], v[60:61], v[88:89], v[52:53]
  v_pk_fma_f32 v[54:55], v[62:63], v[90:91], v[54:55]
  v_pk_mul_f32 v[44:45], v[88:89], v[92:93]
  v_pk_mul_f32 v[46:47], v[90:91], v[94:95]
  v_pk_mul_f32 v[52:53], v[52:53], v[96:97]
  v_pk_mul_f32 v[54:55], v[54:55], v[98:99]
  v_pk_fma_f32 v[48:49], v[48:49], v[96:97], v[44:45]
  v_pk_fma_f32 v[50:51], v[50:51], v[98:99], v[46:47]
  v_pk_fma_f32 v[52:53], v[64:65], v[44:45], v[52:53]
  v_pk_fma_f32 v[54:55], v[66:67], v[46:47], v[54:55]
  v_pk_mul_f32 v[44:45], v[44:45], v[96:97]
  v_pk_mul_f32 v[46:47], v[46:47], v[98:99]
  s_branch K2F
K2F4:
  s_waitcnt lgkmcnt(3)
  buffer_load_dwordx4 v[56:59], v[24:25], s[16:19], 0 idxen offen sc1
  buffer_load_dwordx4 v[60:63], v[26:27], s[16:19], 0 idxen offen sc1
  buffer_load_dwordx4 v[64:67], v[28:29], s[16:19], 0 idxen offen sc1
  buffer_load_dwordx4 v[68:71], v[30:31], s[16:19], 0 idxen offen sc1
  ds_read_u16 v24, v0 offset:65272
  ds_read_u16 v26, v0 offset:65274
  ds_read_u16 v28, v0 offset:65276
  ds_read_u16 v30, v0 offset:65278
  s_nop 0
  s_waitcnt lgkmcnt(4)
  v_mfma_f32_16x16x16_bf16 v[88:91], v[16:17], v[8:9], v[40:43]
  v_mfma_f32_16x16x16_bf16 v[92:95], v[18:19], v[8:9], v[40:43]
  v_mfma_f32_16x16x16_bf16 v[96:99], v[20:21], v[8:9], v[40:43]
  v_mfma_f32_16x16x16_bf16 v[100:103], v[22:23], v[8:9], v[40:43]
  ds_read_b128 v[16:19], v1 offset:96
  ds_read_b128 v[20:23], v1 offset:112
  s_nop 0
  s_waitcnt lgkmcnt(2)
  buffer_load_dwordx4 v[72:75], v[24:25], s[16:19], 0 idxen offen sc1
  buffer_load_dwordx4 v[76:79], v[26:27], s[16:19], 0 idxen offen sc1
  buffer_load_dwordx4 v[80:83], v[28:29], s[16:19], 0 idxen offen sc1
  buffer_load_dwordx4 v[84:87], v[30:31], s[16:19], 0 idxen offen sc1
  ds_read_u16 v24, v0 offset:65264
  ds_read_u16 v26, v0 offset:65266
  ds_read_u16 v28, v0 offset:65268
  ds_read_u16 v30, v0 offset:65270
  s_nop 0
  s_waitcnt lgkmcnt(4)
  v_mfma_f32_16x16x16_bf16 v[104:107], v[16:17], v[8:9], v[40:43]
  v_mfma_f32_16x16x16_bf16 v[108:111], v[18:19], v[8:9], v[40:43]
  v_mfma_f32_16x16x16_bf16 v[112:115], v[20:21], v[8:9], v[40:43]
  v_mfma_f32_16x16x16_bf16 v[116:119], v[22:23], v[8:9], v[40:43]
  ds_read_b128 v[16:19], v1 offset:64
  ds_read_b128 v[20:23], v1 offset:80
  s_waitcnt vmcnt(4)
  v_mfma_f32_16x16x32_bf16 v[88:91], v[4:7], v[56:59], v[88:91]
  v_mfma_f32_16x16x32_bf16 v[92:95], v[4:7], v[60:63], v[92:95]
  v_mfma_f32_16x16x32_bf16 v[96:99], v[4:7], v[64:67], v[96:99]
  v_mfma_f32_16x16x32_bf16 v[100:103], v[4:7], v[68:71], v[100:103]
  s_nop 4
  v_exp_f32 v88, v88 clamp
  v_exp_f32 v89, v89 clamp
  v_exp_f32 v90, v90 clamp
  v_exp_f32 v91, v91 clamp
  v_exp_f32 v92, v92 clamp
  v_exp_f32 v93, v93 clamp
  v_exp_f32 v94, v94 clamp
  v_exp_f32 v95, v95 clamp
  v_exp_f32 v96, v96 clamp
  v_exp_f32 v97, v97 clamp
  v_exp_f32 v98, v98 clamp
  v_exp_f32 v99, v99 clamp
  v_exp_f32 v100, v100 clamp
  v_exp_f32 v101, v101 clamp
  v_exp_f32 v102, v102 clamp
  v_exp_f32 v103, v103 clamp
  v_pk_fma_f32 v[88:89], v[88:89], s[28:29], s[28:29] op_sel:[0,0,1] op_sel_hi:[1,0,1]
  v_pk_fma_f32 v[90:91], v[90:91], s[28:29], s[28:29] op_sel:[0,0,1] op_sel_hi:[1,0,1]
  v_pk_fma_f32 v[92:93], v[92:93], s[28:29], s[28:29] op_sel:[0,0,1] op_sel_hi:[1,0,1]
  v_pk_fma_f32 v[94:95], v[94:95], s[28:29], s[28:29] op_sel:[0,0,1] op_sel_hi:[1,0,1]
  v_pk_fma_f32 v[96:97], v[96:97], s[28:29], s[28:29] op_sel:[0,0,1] op_sel_hi:[1,0,1]
  v_pk_fma_f32 v[98:99], v[98:99], s[28:29], s[28:29] op_sel:[0,0,1] op_sel_hi:[1,0,1]
  v_pk_fma_f32 v[100:101], v[100:101], s[28:29], s[28:29] op_sel:[0,0,1] op_sel_hi:[1,0,1]
  v_pk_fma_f32 v[102:103], v[102:103], s[28:29], s[28:29] op_sel:[0,0,1] op_sel_hi:[1,0,1]
  v_pk_mul_f32 v[52:53], v[56:57], v[92:93]
  v_pk_mul_f32 v[54:55], v[58:59], v[94:95]
  v_pk_add_f32 v[48:49], v[88:89], v[92:93]
  v_pk_add_f32 v[50:51], v[90:91], v[94:95]
  v_pk_fma_f32 v[52:53], v[60:61], v[88:89], v[52:53]
  v_pk_fma_f32 v[54:55], v[62:63], v[90:91], v[54:55]
  v_pk_mul_f32 v[44:45], v[88:89], v[92:93]
  v_pk_mul_f32 v[46:47], v[90:91], v[94:95]
  v_pk_mul_f32 v[52:53], v[52:53], v[96:97]
  v_pk_mul_f32 v[54:55], v[54:55], v[98:99]
  v_pk_fma_f32 v[48:49], v[48:49], v[96:97], v[44:45]
  v_pk_fma_f32 v[50:51], v[50:51], v[98:99], v[46:47]
  v_pk_fma_f32 v[52:53], v[64:65], v[44:45], v[52:53]
  v_pk_fma_f32 v[54:55], v[66:67], v[46:47], v[54:55]
  v_pk_mul_f32 v[44:45], v[44:45], v[96:97]
  v_pk_mul_f32 v[46:47], v[46:47], v[98:99]
  v_pk_mul_f32 v[52:53], v[52:53], v[100:101]
  v_pk_mul_f32 v[54:55], v[54:55], v[102:103]
  v_pk_fma_f32 v[48:49], v[48:49], v[100:101], v[44:45]
  v_pk_fma_f32 v[50:51], v[50:51], v[102:103], v[46:47]
  v_pk_fma_f32 v[52:53], v[68:69], v[44:45], v[52:53]
  v_pk_fma_f32 v[54:55], v[70:71], v[46:47], v[54:55]
  v_pk_mul_f32 v[44:45], v[44:45], v[100:101]
  v_pk_mul_f32 v[46:47], v[46:47], v[102:103]
K2F:
  s_cmp_eq_u32 s47, 0
  s_cbranch_scc1 K2Z
K2LOOP:
  s_cmp_eq_u32 s47, 1
  s_cbranch_scc1 K2L1
  s_cmp_eq_u32 s47, s44
  s_cbranch_scc0 K2Q1
  s_setprio 1
K2Q1:
  s_waitcnt lgkmcnt(0)
  buffer_load_dwordx4 v[56:59], v[24:25], s[16:19], 0 idxen offen sc1
  buffer_load_dwordx4 v[60:63], v[26:27], s[16:19], 0 idxen offen sc1
  buffer_load_dwordx4 v[64:67], v[28:29], s[16:19], 0 idxen offen sc1
  buffer_load_dwordx4 v[68:71], v[30:31], s[16:19], 0 idxen offen sc1
  s_nop 0
  s_waitcnt vmcnt(4)
  v_mfma_f32_16x16x32_bf16 v[104:107], v[4:7], v[72:75], v[104:107]
  v_rcp_f32 v44, v44
  v_rcp_f32 v45, v45
  v_mfma_f32_16x16x32_bf16 v[108:111], v[4:7], v[76:79], v[108:111]
  v_rcp_f32 v46, v46
  v_rcp_f32 v47, v47
  ds_read_u16 v24, v0 offset:65256
  ds_read_u16 v26, v0 offset:65258
  ds_read_u16 v28, v0 offset:65260
  ds_read_u16 v30, v0 offset:65262
  v_mfma_f32_16x16x32_bf16 v[112:115], v[4:7], v[80:83], v[112:115]
  v_exp_f32 v104, v104 clamp
  v_exp_f32 v105, v105 clamp
  v_mfma_f32_16x16x32_bf16 v[116:119], v[4:7], v[84:87], v[116:119]
  v_exp_f32 v106, v106 clamp
  v_exp_f32 v107, v107 clamp
  v_mfma_f32_16x16x16_bf16 v[88:91], v[16:17], v[8:9], v[40:43]
  v_exp_f32 v108, v108 clamp
  v_exp_f32 v109, v109 clamp
  v_mfma_f32_16x16x16_bf16 v[92:95], v[18:19], v[8:9], v[40:43]
  v_exp_f32 v110, v110 clamp
  v_exp_f32 v111, v111 clamp
  v_mfma_f32_16x16x16_bf16 v[96:99], v[20:21], v[8:9], v[40:43]
  v_exp_f32 v112, v112 clamp
  v_exp_f32 v113, v113 clamp
  v_mfma_f32_16x16x16_bf16 v[100:103], v[22:23], v[8:9], v[40:43]
  v_exp_f32 v114, v114 clamp
  v_exp_f32 v115, v115 clamp
  ds_read_b128 v[16:19], v1 offset:32
  ds_read_b128 v[20:23], v1 offset:48
  v_exp_f32 v116, v116 clamp
  v_exp_f32 v117, v117 clamp
  v_exp_f32 v118, v118 clamp
  v_exp_f32 v119, v119 clamp
  v_pk_fma_f32 v[32:33], v[48:49], v[44:45], v[32:33]
  v_pk_fma_f32 v[34:35], v[50:51], v[46:47], v[34:35]
  v_pk_fma_f32 v[36:37], v[52:53], v[44:45], v[36:37]
  v_pk_fma_f32 v[38:39], v[54:55], v[46:47], v[38:39]
  v_pk_fma_f32 v[104:105], v[104:105], s[28:29], s[28:29] op_sel:[0,0,1] op_sel_hi:[1,0,1]
  v_pk_fma_f32 v[106:107], v[106:107], s[28:29], s[28:29] op_sel:[0,0,1] op_sel_hi:[1,0,1]
  v_pk_fma_f32 v[108:109], v[108:109], s[28:29], s[28:29] op_sel:[0,0,1] op_sel_hi:[1,0,1]
  v_pk_fma_f32 v[110:111], v[110:111], s[28:29], s[28:29] op_sel:[0,0,1] op_sel_hi:[1,0,1]
  v_pk_fma_f32 v[112:113], v[112:113], s[28:29], s[28:29] op_sel:[0,0,1] op_sel_hi:[1,0,1]
  v_pk_fma_f32 v[114:115], v[114:115], s[28:29], s[28:29] op_sel:[0,0,1] op_sel_hi:[1,0,1]
  v_pk_fma_f32 v[116:117], v[116:117], s[28:29], s[28:29] op_sel:[0,0,1] op_sel_hi:[1,0,1]
  v_pk_fma_f32 v[118:119], v[118:119], s[28:29], s[28:29] op_sel:[0,0,1] op_sel_hi:[1,0,1]
  v_pk_mul_f32 v[52:53], v[72:73], v[108:109]
  v_pk_mul_f32 v[54:55], v[74:75], v[110:111]
  v_pk_add_f32 v[48:49], v[104:105], v[108:109]
  v_pk_add_f32 v[50:51], v[106:107], v[110:111]
  v_pk_fma_f32 v[52:53], v[76:77], v[104:105], v[52:53]
  v_pk_fma_f32 v[54:55], v[78:79], v[106:107], v[54:55]
  v_pk_mul_f32 v[44:45], v[104:105], v[108:109]
  v_pk_mul_f32 v[46:47], v[106:107], v[110:111]
  v_pk_mul_f32 v[52:53], v[52:53], v[112:113]
  v_pk_mul_f32 v[54:55], v[54:55], v[114:115]
  v_pk_fma_f32 v[48:49], v[48:49], v[112:113], v[44:45]
  v_pk_fma_f32 v[50:51], v[50:51], v[114:115], v[46:47]
  v_pk_fma_f32 v[52:53], v[80:81], v[44:45], v[52:53]
  v_pk_fma_f32 v[54:55], v[82:83], v[46:47], v[54:55]
  v_pk_mul_f32 v[44:45], v[44:45], v[112:113]
  v_pk_mul_f32 v[46:47], v[46:47], v[114:115]
  v_pk_mul_f32 v[52:53], v[52:53], v[116:117]
  v_pk_mul_f32 v[54:55], v[54:55], v[118:119]
  v_pk_fma_f32 v[48:49], v[48:49], v[116:117], v[44:45]
  v_pk_fma_f32 v[50:51], v[50:51], v[118:119], v[46:47]
  v_pk_fma_f32 v[52:53], v[84:85], v[44:45], v[52:53]
  v_pk_fma_f32 v[54:55], v[86:87], v[46:47], v[54:55]
  v_pk_mul_f32 v[44:45], v[44:45], v[116:117]
  v_pk_mul_f32 v[46:47], v[46:47], v[118:119]
  s_cmp_eq_u32 s47, 2
  s_cbranch_scc1 K2L0
  s_cmp_eq_u32 s47, s43
  s_cbranch_scc0 K2Q0
  s_setprio 1
K2Q0:
  s_waitcnt lgkmcnt(0)
  buffer_load_dwordx4 v[72:75], v[24:25], s[16:19], 0 idxen offen sc1
  buffer_load_dwordx4 v[76:79], v[26:27], s[16:19], 0 idxen offen sc1
  buffer_load_dwordx4 v[80:83], v[28:29], s[16:19], 0 idxen offen sc1
  buffer_load_dwordx4 v[84:87], v[30:31], s[16:19], 0 idxen offen sc1
  s_nop 0
  s_waitcnt vmcnt(4)
  v_mfma_f32_16x16x32_bf16 v[88:91], v[4:7], v[56:59], v[88:91]
  v_rcp_f32 v44, v44
  v_rcp_f32 v45, v45
  v_mfma_f32_16x16x32_bf16 v[92:95], v[4:7], v[60:63], v[92:95]
  v_rcp_f32 v46, v46
  v_rcp_f32 v47, v47
  ds_read_u16 v24, v0 offset:65248
  ds_read_u16 v26, v0 offset:65250
  ds_read_u16 v28, v0 offset:65252
  ds_read_u16 v30, v0 offset:65254
  v_mfma_f32_16x16x32_bf16 v[96:99], v[4:7], v[64:67], v[96:99]
  v_exp_f32 v88, v88 clamp
  v_exp_f32 v89, v89 clamp
  v_mfma_f32_16x16x32_bf16 v[100:103], v[4:7], v[68:71], v[100:103]
  v_exp_f32 v90, v90 clamp
  v_exp_f32 v91, v91 clamp
  v_mfma_f32_16x16x16_bf16 v[104:107], v[16:17], v[8:9], v[40:43]
  v_exp_f32 v92, v92 clamp
  v_exp_f32 v93, v93 clamp
  v_mfma_f32_16x16x16_bf16 v[108:111], v[18:19], v[8:9], v[40:43]
  v_exp_f32 v94, v94 clamp
  v_exp_f32 v95, v95 clamp
  v_mfma_f32_16x16x16_bf16 v[112:115], v[20:21], v[8:9], v[40:43]
  v_exp_f32 v96, v96 clamp
  v_exp_f32 v97, v97 clamp
  v_mfma_f32_16x16x16_bf16 v[116:119], v[22:23], v[8:9], v[40:43]
  v_exp_f32 v98, v98 clamp
  v_exp_f32 v99, v99 clamp
  ds_read_b128 v[16:19], v1 offset:0
  ds_read_b128 v[20:23], v1 offset:16
  v_exp_f32 v100, v100 clamp
  v_exp_f32 v101, v101 clamp
  v_exp_f32 v102, v102 clamp
  v_exp_f32 v103, v103 clamp
  v_pk_fma_f32 v[32:33], v[48:49], v[44:45], v[32:33]
  v_pk_fma_f32 v[34:35], v[50:51], v[46:47], v[34:35]
  v_pk_fma_f32 v[36:37], v[52:53], v[44:45], v[36:37]
  v_pk_fma_f32 v[38:39], v[54:55], v[46:47], v[38:39]
  v_pk_fma_f32 v[88:89], v[88:89], s[28:29], s[28:29] op_sel:[0,0,1] op_sel_hi:[1,0,1]
  v_pk_fma_f32 v[90:91], v[90:91], s[28:29], s[28:29] op_sel:[0,0,1] op_sel_hi:[1,0,1]
  v_pk_fma_f32 v[92:93], v[92:93], s[28:29], s[28:29] op_sel:[0,0,1] op_sel_hi:[1,0,1]
  v_pk_fma_f32 v[94:95], v[94:95], s[28:29], s[28:29] op_sel:[0,0,1] op_sel_hi:[1,0,1]
  v_pk_fma_f32 v[96:97], v[96:97], s[28:29], s[28:29] op_sel:[0,0,1] op_sel_hi:[1,0,1]
  v_pk_fma_f32 v[98:99], v[98:99], s[28:29], s[28:29] op_sel:[0,0,1] op_sel_hi:[1,0,1]
  v_pk_fma_f32 v[100:101], v[100:101], s[28:29], s[28:29] op_sel:[0,0,1] op_sel_hi:[1,0,1]
  v_pk_fma_f32 v[102:103], v[102:103], s[28:29], s[28:29] op_sel:[0,0,1] op_sel_hi:[1,0,1]
  v_pk_mul_f32 v[52:53], v[56:57], v[92:93]
  v_pk_mul_f32 v[54:55], v[58:59], v[94:95]
  v_pk_add_f32 v[48:49], v[88:89], v[92:93]
  v_pk_add_f32 v[50:51], v[90:91], v[94:95]
  v_pk_fma_f32 v[52:53], v[60:61], v[88:89], v[52:53]
  v_pk_fma_f32 v[54:55], v[62:63], v[90:91], v[54:55]
  v_pk_mul_f32 v[44:45], v[88:89], v[92:93]
  v_pk_mul_f32 v[46:47], v[90:91], v[94:95]
  v_pk_mul_f32 v[52:53], v[52:53], v[96:97]
  v_pk_mul_f32 v[54:55], v[54:55], v[98:99]
  v_pk_fma_f32 v[48:49], v[48:49], v[96:97], v[44:45]
  v_pk_fma_f32 v[50:51], v[50:51], v[98:99], v[46:47]
  v_pk_fma_f32 v[52:53], v[64:65], v[44:45], v[52:53]
  v_pk_fma_f32 v[54:55], v[66:67], v[46:47], v[54:55]
  v_pk_mul_f32 v[44:45], v[44:45], v[96:97]
  v_pk_mul_f32 v[46:47], v[46:47], v[98:99]
  v_pk_mul_f32 v[52:53], v[52:53], v[100:101]
  v_pk_mul_f32 v[54:55], v[54:55], v[102:103]
  v_pk_fma_f32 v[48:49], v[48:49], v[100:101], v[44:45]
  v_pk_fma_f32 v[50:51], v[50:51], v[102:103], v[46:47]
  v_pk_fma_f32 v[52:53], v[68:69], v[44:45], v[52:53]
  v_pk_fma_f32 v[54:55], v[70:71], v[46:47], v[54:55]
  v_pk_mul_f32 v[44:45], v[44:45], v[100:101]
  v_pk_mul_f32 v[46:47], v[46:47], v[102:103]
  v_lshl_add_u64 v[0:1], v[0:1], 0, s[26:27]
  s_sub_u32 s47, s47, 2
  s_branch K2LOOP
  s_nop 0
K2Z:
  s_waitcnt vmcnt(0)
  ds_read_addtid_b32 v124 offset:22880
  ds_read_b128 v[40:43], v2 offset:44544
  ds_read_u16_d16_hi v120, v10 offset:0
  ds_read_u16_d16_hi v121, v10 offset:2
  ds_read_u16_d16_hi v122, v10 offset:4
  ds_read_u16_d16_hi v123, v10 offset:6
  s_branch K2EPI
  s_nop 0
K2L0:
  s_cmp_eq_u32 s44, 0
  s_cbranch_scc1 K2Q2
  s_setprio 0
K2Q2:
  s_waitcnt vmcnt(0)
  v_mfma_f32_16x16x32_bf16 v[88:91], v[4:7], v[56:59], v[88:91]
  v_rcp_f32 v44, v44
  v_rcp_f32 v45, v45
  v_mfma_f32_16x16x32_bf16 v[92:95], v[4:7], v[60:63], v[92:95]
  v_rcp_f32 v46, v46
  v_rcp_f32 v47, v47
  ds_read_addtid_b32 v124 offset:22880
  ds_read_b128 v[40:43], v2 offset:44544
  ds_read_u16_d16_hi v120, v10 offset:0
  ds_read_u16_d16_hi v121, v10 offset:2
  ds_read_u16_d16_hi v122, v10 offset:4
  ds_read_u16_d16_hi v123, v10 offset:6
  v_mfma_f32_16x16x32_bf16 v[96:99], v[4:7], v[64:67], v[96:99]
  v_exp_f32 v88, v88 clamp
  v_exp_f32 v89, v89 clamp
  v_mfma_f32_16x16x32_bf16 v[100:103], v[4:7], v[68:71], v[100:103]
  v_exp_f32 v90, v90 clamp
  v_exp_f32 v91, v91 clamp
  v_exp_f32 v92, v92 clamp
  v_exp_f32 v93, v93 clamp
  v_exp_f32 v94, v94 clamp
  v_exp_f32 v95, v95 clamp
  v_exp_f32 v96, v96 clamp
  v_exp_f32 v97, v97 clamp
  v_exp_f32 v98, v98 clamp
  v_exp_f32 v99, v99 clamp
  v_exp_f32 v100, v100 clamp
  v_exp_f32 v101, v101 clamp
  v_exp_f32 v102, v102 clamp
  v_exp_f32 v103, v103 clamp
  v_pk_fma_f32 v[32:33], v[48:49], v[44:45], v[32:33]
  v_pk_fma_f32 v[34:35], v[50:51], v[46:47], v[34:35]
  v_pk_fma_f32 v[36:37], v[52:53], v[44:45], v[36:37]
  v_pk_fma_f32 v[38:39], v[54:55], v[46:47], v[38:39]
  v_pk_fma_f32 v[88:89], v[88:89], s[28:29], s[28:29] op_sel:[0,0,1] op_sel_hi:[1,0,1]
  v_pk_fma_f32 v[90:91], v[90:91], s[28:29], s[28:29] op_sel:[0,0,1] op_sel_hi:[1,0,1]
  v_pk_fma_f32 v[92:93], v[92:93], s[28:29], s[28:29] op_sel:[0,0,1] op_sel_hi:[1,0,1]
  v_pk_fma_f32 v[94:95], v[94:95], s[28:29], s[28:29] op_sel:[0,0,1] op_sel_hi:[1,0,1]
  v_pk_fma_f32 v[96:97], v[96:97], s[28:29], s[28:29] op_sel:[0,0,1] op_sel_hi:[1,0,1]
  v_pk_fma_f32 v[98:99], v[98:99], s[28:29], s[28:29] op_sel:[0,0,1] op_sel_hi:[1,0,1]
  v_pk_fma_f32 v[100:101], v[100:101], s[28:29], s[28:29] op_sel:[0,0,1] op_sel_hi:[1,0,1]
  v_pk_fma_f32 v[102:103], v[102:103], s[28:29], s[28:29] op_sel:[0,0,1] op_sel_hi:[1,0,1]
  v_pk_mul_f32 v[52:53], v[56:57], v[92:93]
  v_pk_mul_f32 v[54:55], v[58:59], v[94:95]
  v_pk_add_f32 v[48:49], v[88:89], v[92:93]
  v_pk_add_f32 v[50:51], v[90:91], v[94:95]
  v_pk_fma_f32 v[52:53], v[60:61], v[88:89], v[52:53]
  v_pk_fma_f32 v[54:55], v[62:63], v[90:91], v[54:55]
  v_pk_mul_f32 v[44:45], v[88:89], v[92:93]
  v_pk_mul_f32 v[46:47], v[90:91], v[94:95]
  v_pk_mul_f32 v[52:53], v[52:53], v[96:97]
  v_pk_mul_f32 v[54:55], v[54:55], v[98:99]
  v_pk_fma_f32 v[48:49], v[48:49], v[96:97], v[44:45]
  v_pk_fma_f32 v[50:51], v[50:51], v[98:99], v[46:47]
  v_pk_fma_f32 v[52:53], v[64:65], v[44:45], v[52:53]
  v_pk_fma_f32 v[54:55], v[66:67], v[46:47], v[54:55]
  v_pk_mul_f32 v[44:45], v[44:45], v[96:97]
  v_pk_mul_f32 v[46:47], v[46:47], v[98:99]
  v_pk_mul_f32 v[52:53], v[52:53], v[100:101]
  v_pk_mul_f32 v[54:55], v[54:55], v[102:103]
  v_pk_fma_f32 v[48:49], v[48:49], v[100:101], v[44:45]
  v_pk_fma_f32 v[50:51], v[50:51], v[102:103], v[46:47]
  v_pk_fma_f32 v[52:53], v[68:69], v[44:45], v[52:53]
  v_pk_fma_f32 v[54:55], v[70:71], v[46:47], v[54:55]
  v_pk_mul_f32 v[44:45], v[44:45], v[100:101]
  v_pk_mul_f32 v[46:47], v[46:47], v[102:103]
  s_branch K2EPI
  s_nop 0
K2L1:
  s_cmp_eq_u32 s44, 0
  s_cbranch_scc1 K2Q3
  s_setprio 0
K2Q3:
  s_waitcnt vmcnt(0)
  v_mfma_f32_16x16x32_bf16 v[104:107], v[4:7], v[72:75], v[104:107]
  v_rcp_f32 v44, v44
  v_rcp_f32 v45, v45
  v_mfma_f32_16x16x32_bf16 v[108:111], v[4:7], v[76:79], v[108:111]
  v_rcp_f32 v46, v46
  v_rcp_f32 v47, v47
  ds_read_addtid_b32 v124 offset:22880
  ds_read_b128 v[40:43], v2 offset:44544
  ds_read_u16_d16_hi v120, v10 offset:0
  ds_read_u16_d16_hi v121, v10 offset:2
  ds_read_u16_d16_hi v122, v10 offset:4
  ds_read_u16_d16_hi v123, v10 offset:6
  v_mfma_f32_16x16x32_bf16 v[112:115], v[4:7], v[80:83], v[112:115]
  v_exp_f32 v104, v104 clamp
  v_exp_f32 v105, v105 clamp
  v_mfma_f32_16x16x32_bf16 v[116:119], v[4:7], v[84:87], v[116:119]
  v_exp_f32 v106, v106 clamp
  v_exp_f32 v107, v107 clamp
  v_exp_f32 v108, v108 clamp
  v_exp_f32 v109, v109 clamp
  v_exp_f32 v110, v110 clamp
  v_exp_f32 v111, v111 clamp
  v_exp_f32 v112, v112 clamp
  v_exp_f32 v113, v113 clamp
  v_exp_f32 v114, v114 clamp
  v_exp_f32 v115, v115 clamp
  v_exp_f32 v116, v116 clamp
  v_exp_f32 v117, v117 clamp
  v_exp_f32 v118, v118 clamp
  v_exp_f32 v119, v119 clamp
  v_pk_fma_f32 v[32:33], v[48:49], v[44:45], v[32:33]
  v_pk_fma_f32 v[34:35], v[50:51], v[46:47], v[34:35]
  v_pk_fma_f32 v[36:37], v[52:53], v[44:45], v[36:37]
  v_pk_fma_f32 v[38:39], v[54:55], v[46:47], v[38:39]
  v_pk_fma_f32 v[104:105], v[104:105], s[28:29], s[28:29] op_sel:[0,0,1] op_sel_hi:[1,0,1]
  v_pk_fma_f32 v[106:107], v[106:107], s[28:29], s[28:29] op_sel:[0,0,1] op_sel_hi:[1,0,1]
  v_pk_fma_f32 v[108:109], v[108:109], s[28:29], s[28:29] op_sel:[0,0,1] op_sel_hi:[1,0,1]
  v_pk_fma_f32 v[110:111], v[110:111], s[28:29], s[28:29] op_sel:[0,0,1] op_sel_hi:[1,0,1]
  v_pk_fma_f32 v[112:113], v[112:113], s[28:29], s[28:29] op_sel:[0,0,1] op_sel_hi:[1,0,1]
  v_pk_fma_f32 v[114:115], v[114:115], s[28:29], s[28:29] op_sel:[0,0,1] op_sel_hi:[1,0,1]
  v_pk_fma_f32 v[116:117], v[116:117], s[28:29], s[28:29] op_sel:[0,0,1] op_sel_hi:[1,0,1]
  v_pk_fma_f32 v[118:119], v[118:119], s[28:29], s[28:29] op_sel:[0,0,1] op_sel_hi:[1,0,1]
  v_pk_mul_f32 v[52:53], v[72:73], v[108:109]
  v_pk_mul_f32 v[54:55], v[74:75], v[110:111]
  v_pk_add_f32 v[48:49], v[104:105], v[108:109]
  v_pk_add_f32 v[50:51], v[106:107], v[110:111]
  v_pk_fma_f32 v[52:53], v[76:77], v[104:105], v[52:53]
  v_pk_fma_f32 v[54:55], v[78:79], v[106:107], v[54:55]
  v_pk_mul_f32 v[44:45], v[104:105], v[108:109]
  v_pk_mul_f32 v[46:47], v[106:107], v[110:111]
  v_pk_mul_f32 v[52:53], v[52:53], v[112:113]
  v_pk_mul_f32 v[54:55], v[54:55], v[114:115]
  v_pk_fma_f32 v[48:49], v[48:49], v[112:113], v[44:45]
  v_pk_fma_f32 v[50:51], v[50:51], v[114:115], v[46:47]
  v_pk_fma_f32 v[52:53], v[80:81], v[44:45], v[52:53]
  v_pk_fma_f32 v[54:55], v[82:83], v[46:47], v[54:55]
  v_pk_mul_f32 v[44:45], v[44:45], v[112:113]
  v_pk_mul_f32 v[46:47], v[46:47], v[114:115]
  v_pk_mul_f32 v[52:53], v[52:53], v[116:117]
  v_pk_mul_f32 v[54:55], v[54:55], v[118:119]
  v_pk_fma_f32 v[48:49], v[48:49], v[116:117], v[44:45]
  v_pk_fma_f32 v[50:51], v[50:51], v[118:119], v[46:47]
  v_pk_fma_f32 v[52:53], v[84:85], v[44:45], v[52:53]
  v_pk_fma_f32 v[54:55], v[86:87], v[46:47], v[54:55]
  v_pk_mul_f32 v[44:45], v[44:45], v[116:117]
  v_pk_mul_f32 v[46:47], v[46:47], v[118:119]
K2EPI:
  v_rcp_f32 v44, v44
  v_rcp_f32 v45, v45
  v_rcp_f32 v46, v46
  v_rcp_f32 v47, v47
  v_pk_fma_f32 v[32:33], v[48:49], v[44:45], v[32:33]
  v_pk_fma_f32 v[34:35], v[50:51], v[46:47], v[34:35]
  v_pk_fma_f32 v[36:37], v[52:53], v[44:45], v[36:37]
  v_pk_fma_f32 v[38:39], v[54:55], v[46:47], v[38:39]
  v_rcp_f32 v32, v32
  v_rcp_f32 v33, v33
  v_rcp_f32 v34, v34
  v_rcp_f32 v35, v35
K2U0:
  s_waitcnt lgkmcnt(0)
  v_readfirstlane_b32 s46, v124
  s_cmp_lg_u32 s46, 4
  s_cbranch_scc1 K2U1
  v_pk_fma_f32 v[40:41], v[36:37], v[32:33], v[40:41]
  v_pk_fma_f32 v[42:43], v[38:39], v[34:35], v[42:43]
  v_max_f32 v40, 0, v40
  v_max_f32 v41, 0, v41
  v_max_f32 v42, 0, v42
  v_max_f32 v43, 0, v43
  v_pk_add_f32 v[40:41], v[40:41], v[120:121]
  v_pk_add_f32 v[42:43], v[42:43], v[122:123]
  v_cvt_pk_bf16_f32 v120, v40, v41
  v_cvt_pk_bf16_f32 v121, v42, v43
  buffer_store_dwordx2 v[120:121], v3, s[20:23], 0 offen
  s_cmp_ge_u32 s33, 4
  s_cbranch_scc1 K2FIN
  s_mov_b32 s33, 4
  s_mov_b32 s44, 2
  s_mov_b32 s43, 3
  v_add_u32 v11, s61, v11
  v_add_u32 v12, s61, v12
  s_setprio 2
  s_branch K2JOB
K2U1:
  s_setprio 0
  ds_read_addtid_b32 v124 offset:22880
  s_waitcnt lgkmcnt(0)
  v_readfirstlane_b32 s46, v124
  s_cmp_lg_u32 s46, 4
  s_cbranch_scc1 K2U1
  ds_read_b128 v[40:43], v2 offset:44544
  s_branch K2U0
  s_nop 0
K2FIN:
  s_lshl4_add_u32 s46, s2, s33
  s_cmp_lg_u32 s46, 15
  s_cbranch_scc1 K2FI2
  v_mov_b32 v56, 0
  ds_read_b128 v[60:63], v56 offset:22928
  s_mov_b64 exec, 1
  s_waitcnt lgkmcnt(0)
  global_atomic_cmpswap_x2 v56, v[60:63], s[24:25] sc1
  s_mov_b64 exec, -1
K2FI2:
  s_endpgm
KEND:
  s_endpgm
RTO:
  s_mov_b32 s57, 0
  s_waitcnt vmcnt(0) lgkmcnt(0)
  v_mov_b32 v56, 0
  s_bfm_b64 exec, 20, 0
  v_lshlrev_b32 v126, 4, v124
  v_mov_b32 v127, 65536
  ds_max_u32 v126, v127 offset:22528
  s_mov_b64 exec, -1
  s_branch RP1
ROV:
  s_bfm_b64 exec, 20, 0
  v_lshlrev_b32 v126, 4, v124
  v_mov_b32 v127, 65536
  ds_max_u32 v126, v127 offset:22528
  s_mov_b64 exec, -1
  s_waitcnt lgkmcnt(0)
  s_branch ROV1
SOV:
  s_bfm_b64 exec, 20, 0
  v_lshlrev_b32 v126, 4, v124
  v_mov_b32 v127, 65536
  ds_max_u32 v126, v127 offset:22528
  s_mov_b64 exec, -1
  s_branch SOV1
FPR:
  global_load_dwordx2 v[120:121], v118, s[24:25] sc1
  s_sub_u32 s39, s39, 1
  s_waitcnt vmcnt(0)
  s_cbranch_scc0 FP
  s_bfm_b64 exec, 20, 0
  v_lshlrev_b32 v126, 4, v124
  v_mov_b32 v127, 131072
  ds_max_u32 v126, v127 offset:22528
  s_mov_b64 exec, -1
  s_branch FP1
RR0:
  buffer_load_dwordx4 v[64:67], v98, s[8:11], 0 offen sc1
  s_sub_u32 s57, s57, 1
  s_waitcnt vmcnt(0)
  s_cbranch_scc0 RB0
  s_mov_b32 s57, 0
  s_bfm_b64 exec, 20, 0
  v_lshlrev_b32 v126, 4, v124
  v_mov_b32 v127, 65536
  ds_max_u32 v126, v127 offset:22528
  s_mov_b64 exec, -1
  v_mov_b32 v67, 0
  s_mov_b64 s[40:41], 0
  s_mov_b64 exec, 0
  s_waitcnt lgkmcnt(0)
  s_branch RC0
RR1:
  buffer_load_dwordx4 v[68:71], v99, s[8:11], 0 offen sc1
  s_sub_u32 s57, s57, 1
  s_waitcnt vmcnt(0)
  s_cbranch_scc0 RB1
  s_mov_b32 s57, 0
  s_bfm_b64 exec, 20, 0
  v_lshlrev_b32 v126, 4, v124
  v_mov_b32 v127, 65536
  ds_max_u32 v126, v127 offset:22528
  s_mov_b64 exec, -1
  v_mov_b32 v71, 0
  s_mov_b64 s[42:43], 0
  s_mov_b64 exec, 0
  s_waitcnt lgkmcnt(0)
  s_branch RC1
RR2:
  buffer_load_dwordx4 v[72:75], v100, s[8:11], 0 offen sc1
  s_sub_u32 s57, s57, 1
  s_waitcnt vmcnt(0)
  s_cbranch_scc0 RB2
  s_mov_b32 s57, 0
  s_bfm_b64 exec, 20, 0
  v_lshlrev_b32 v126, 4, v124
  v_mov_b32 v127, 65536
  ds_max_u32 v126, v127 offset:22528
  s_mov_b64 exec, -1
  v_mov_b32 v75, 0
  s_mov_b64 s[44:45], 0
  s_mov_b64 exec, 0
  s_waitcnt lgkmcnt(0)
  s_branch RC2
RR3:
  buffer_load_dwordx4 v[76:79], v101, s[8:11], 0 offen sc1
  s_sub_u32 s57, s57, 1
  s_waitcnt vmcnt(0)
  s_cbranch_scc0 RB3
  s_mov_b32 s57, 0
  s_bfm_b64 exec, 20, 0
  v_lshlrev_b32 v126, 4, v124
  v_mov_b32 v127, 65536
  ds_max_u32 v126, v127 offset:22528
  s_mov_b64 exec, -1
  v_mov_b32 v79, 0
  s_mov_b64 s[46:47], 0
  s_mov_b64 exec, 0
  s_waitcnt lgkmcnt(0)
  s_branch RC3
RR4:
  buffer_load_dwordx4 v[80:83], v102, s[8:11], 0 offen sc1
  s_sub_u32 s57, s57, 1
  s_waitcnt vmcnt(0)
  s_cbranch_scc0 RB4
  s_mov_b32 s57, 0
  s_bfm_b64 exec, 20, 0
  v_lshlrev_b32 v126, 4, v124
  v_mov_b32 v127, 65536
  ds_max_u32 v126, v127 offset:22528
  s_mov_b64 exec, -1
  v_mov_b32 v83, 0
  s_mov_b64 s[48:49], 0
  s_mov_b64 exec, 0
  s_waitcnt lgkmcnt(0)
  s_branch RC4
RR5:
  buffer_load_dwordx4 v[84:87], v103, s[8:11], 0 offen sc1
  s_sub_u32 s57, s57, 1
  s_waitcnt vmcnt(0)
  s_cbranch_scc0 RB5
  s_mov_b32 s57, 0
  s_bfm_b64 exec, 20, 0
  v_lshlrev_b32 v126, 4, v124
  v_mov_b32 v127, 65536
  ds_max_u32 v126, v127 offset:22528
  s_mov_b64 exec, -1
  v_mov_b32 v87, 0
  s_mov_b64 s[50:51], 0
  s_mov_b64 exec, 0
  s_waitcnt lgkmcnt(0)
  s_branch RC5
RR6:
  buffer_load_dwordx4 v[88:91], v104, s[8:11], 0 offen sc1
  s_sub_u32 s57, s57, 1
  s_waitcnt vmcnt(0)
  s_cbranch_scc0 RB6
  s_mov_b32 s57, 0
  s_bfm_b64 exec, 20, 0
  v_lshlrev_b32 v126, 4, v124
  v_mov_b32 v127, 65536
  ds_max_u32 v126, v127 offset:22528
  s_mov_b64 exec, -1
  v_mov_b32 v91, 0
  s_mov_b64 s[52:53], 0
  s_mov_b64 exec, 0
  s_waitcnt lgkmcnt(0)
  s_branch RC6
RR7:
  buffer_load_dwordx4 v[92:95], v105, s[8:11], 0 offen sc1
  s_sub_u32 s57, s57, 1
  s_waitcnt vmcnt(0)
  s_cbranch_scc0 RB7
  s_mov_b32 s57, 0
  s_bfm_b64 exec, 20, 0
  v_lshlrev_b32 v126, 4, v124
  v_mov_b32 v127, 65536
  ds_max_u32 v126, v127 offset:22528
  s_mov_b64 exec, -1
  v_mov_b32 v95, 0
  s_mov_b64 s[54:55], 0
  s_mov_b64 exec, 0
  s_waitcnt lgkmcnt(0)
  s_branch RC7
K2SLOW:
  s_barrier
  s_mov_b32 s63, s46
  s_load_dwordx16 s[40:55], s[0:1], 0
  s_load_dwordx2 s[56:57], s[0:1], 64
  s_cmp_lg_u32 s33, 15
  s_cbranch_scc1 SL0
  v_mov_b32 v56, 0
  ds_read_b128 v[60:63], v56 offset:22928
  s_mov_b64 exec, 1
  s_waitcnt lgkmcnt(0)
  global_atomic_cmpswap_x2 v56, v[60:63], s[24:25] sc1
  s_mov_b64 exec, -1
SL0:
  s_waitcnt vmcnt(0) lgkmcnt(0)
  v_lshlrev_b32 v56, 4, v0
  v_add_u32 v56, 65280, v56
  v_and_b32 v124, 63, v0
  v_lshrrev_b32 v126, 4, v124
  ds_write_b128 v56, v[36:39]
  ds_write_b128 v56, v[36:39] offset:16384
  ds_write_b128 v56, v[36:39] offset:32768
  s_cmp_lt_u32 s63, 0x18000
  s_cbranch_scc1 SL3
  s_cmp_ge_u32 s33, 4
  s_cbranch_scc1 SL1
  v_lshlrev_b32 v2, 1, v124
  v_lshlrev_b32 v1, 4, v124
  v_and_b32 v2, 0x20, v2
  v_and_b32 v1, 0x70, v1
  s_mul_i32 s38, s33, 2112
  v_xor_b32 v2, v2, v1
  v_lshrrev_b32 v1, 3, v124
  s_and_b32 s38, s38, 6208
  s_lshl_b32 s39, s30, 7
  v_lshl_or_b32 v1, v1, 8, v2
  s_or_b32 s38, s38, s39
  v_xor_b32 v1, s38, v1
  s_movk_i32 s58, 7168
  s_movk_i32 s59, 14336
  s_movk_i32 s60, 21504
  s_lshl_b32 s38, s33, 12
  s_add_u32 m0, s38, 117504
  s_mov_b64 s[64:65], s[50:51]
  s_mov_b32 s66, 32768
  s_mov_b32 s67, 0x00020000
  s_mov_b64 s[68:69], s[56:57]
  s_mov_b64 s[70:71], s[66:67]
  buffer_load_dwordx4 v1, s[64:67], 0 offen offset:0  lds
  buffer_load_dwordx4 v1, s[64:67], s58 offen offset:1024  lds
  buffer_load_dwordx4 v1, s[64:67], s59 offen offset:2048  lds
  buffer_load_dwordx4 v1, s[64:67], s60 offen offset:3072  lds
  s_add_u32 m0, s38, 133888
  s_nop 0
  buffer_load_dwordx4 v1, s[68:71], 0 offen offset:0  lds
  buffer_load_dwordx4 v1, s[68:71], s58 offen offset:1024  lds
  buffer_load_dwordx4 v1, s[68:71], s59 offen offset:2048  lds
  buffer_load_dwordx4 v1, s[68:71], s60 offen offset:3072  lds
  s_waitcnt vmcnt(0)
SL1:
  s_barrier
  s_cmp_lt_u32 s33, 6
  s_cbranch_scc1 SL3
  s_lshl_b32 s59, s33, 1
  s_and_b32 s59, s59, 2
  s_sub_u32 s39, s33, 6
  v_and_b32 v1, 15, v0
  v_and_b32 v2, 48, v0
  s_lshr_b32 s39, s39, 1
  v_lshl_or_b32 v1, v1, 15, v2
  s_lshl_b32 s39, s39, 19
  v_add_u32 v1, s39, v1
  v_bfe_u32 v2, v124, 2, 2
  v_bfe_u32 v3, v124, 3, 2
  v_lshl_or_b32 v2, v126, 5, v2
  v_xor_b32 v3, s59, v3
  v_lshl_or_b32 v2, v2, 2, v3
  v_and_b32 v3, 3, v124
  v_lshl_or_b32 v2, v2, 2, v3
  v_lshlrev_b32 v2, 3, v2
  v_add_u32 v2, 117504, v2
  v_xor_b32 v3, 32, v2
  s_mul_i32 s64, s30, 2621440
  s_add_u32 s64, s64, 3145728
  s_add_u32 s64, s24, s64
  s_addc_u32 s65, s25, 0
  s_mov_b64 s[66:67], s[6:7]
  s_mov_b32 s56, 3216550459
  s_mov_b32 s57, 0x07060100
  s_mov_b32 s58, 0x07060302
  ds_read_b64_tr_b16 v[32:33], v2 offset:0
  ds_read_b64_tr_b16 v[34:35], v2 offset:512
  ds_read_b64_tr_b16 v[36:37], v2 offset:1024
  ds_read_b64_tr_b16 v[38:39], v2 offset:1536
  ds_read_b64_tr_b16 v[40:41], v2 offset:2048
  ds_read_b64_tr_b16 v[42:43], v2 offset:2560
  ds_read_b64_tr_b16 v[44:45], v2 offset:3072
  ds_read_b64_tr_b16 v[46:47], v2 offset:3584
  ds_read_b64_tr_b16 v[48:49], v2 offset:16384
  ds_read_b64_tr_b16 v[50:51], v2 offset:16896
  ds_read_b64_tr_b16 v[52:53], v2 offset:17408
  ds_read_b64_tr_b16 v[54:55], v2 offset:17920
  ds_read_b64_tr_b16 v[56:57], v2 offset:18432
  ds_read_b64_tr_b16 v[58:59], v2 offset:18944
  ds_read_b64_tr_b16 v[60:61], v2 offset:19456
  ds_read_b64_tr_b16 v[62:63], v2 offset:19968
  ds_read_b64_tr_b16 v[64:65], v3 offset:0
  ds_read_b64_tr_b16 v[66:67], v3 offset:512
  ds_read_b64_tr_b16 v[68:69], v3 offset:1024
  ds_read_b64_tr_b16 v[70:71], v3 offset:1536
  ds_read_b64_tr_b16 v[72:73], v3 offset:2048
  ds_read_b64_tr_b16 v[74:75], v3 offset:2560
  ds_read_b64_tr_b16 v[76:77], v3 offset:3072
  ds_read_b64_tr_b16 v[78:79], v3 offset:3584
  ds_read_b64_tr_b16 v[80:81], v3 offset:16384
  ds_read_b64_tr_b16 v[82:83], v3 offset:16896
  ds_read_b64_tr_b16 v[84:85], v3 offset:17408
  ds_read_b64_tr_b16 v[86:87], v3 offset:17920
  ds_read_b64_tr_b16 v[88:89], v3 offset:18432
  ds_read_b64_tr_b16 v[90:91], v3 offset:18944
  ds_read_b64_tr_b16 v[92:93], v3 offset:19456
  ds_read_b64_tr_b16 v[94:95], v3 offset:19968
  s_lshl_b32 s59, s59, 6
  s_mov_b32 s38, 0
SL2:
  buffer_load_dwordx4 v[96:99], v1, s[4:7], s38 offen offset:0
  buffer_load_dwordx4 v[100:103], v1, s[4:7], s38 offen offset:64
  buffer_load_dwordx4 v[104:107], v1, s[4:7], s38 offen offset:128
  buffer_load_dwordx4 v[108:111], v1, s[4:7], s38 offen offset:192
  s_waitcnt vmcnt(0) lgkmcnt(0)
  v_mfma_f32_16x16x32_bf16 v[112:115], v[32:35], v[96:99], 0
  v_mfma_f32_16x16x32_bf16 v[116:119], v[48:51], v[96:99], 0
  v_mfma_f32_16x16x32_bf16 v[112:115], v[36:39], v[100:103], v[112:115]
  v_mfma_f32_16x16x32_bf16 v[116:119], v[52:55], v[100:103], v[116:119]
  v_mfma_f32_16x16x32_bf16 v[112:115], v[40:43], v[104:107], v[112:115]
  v_mfma_f32_16x16x32_bf16 v[116:119], v[56:59], v[104:107], v[116:119]
  v_mfma_f32_16x16x32_bf16 v[112:115], v[44:47], v[108:111], v[112:115]
  v_mfma_f32_16x16x32_bf16 v[116:119], v[60:63], v[108:111], v[116:119]
  v_mfma_f32_16x16x32_bf16 v[120:123], v[64:67], v[96:99], 0
  v_mfma_f32_16x16x32_bf16 v[16:19], v[80:83], v[96:99], 0
  v_mfma_f32_16x16x32_bf16 v[120:123], v[68:71], v[100:103], v[120:123]
  v_mfma_f32_16x16x32_bf16 v[16:19], v[84:87], v[100:103], v[16:19]
  v_mfma_f32_16x16x32_bf16 v[120:123], v[72:75], v[104:107], v[120:123]
  v_mfma_f32_16x16x32_bf16 v[16:19], v[88:91], v[104:107], v[16:19]
  v_mfma_f32_16x16x32_bf16 v[120:123], v[76:79], v[108:111], v[120:123]
  v_mfma_f32_16x16x32_bf16 v[16:19], v[92:95], v[108:111], v[16:19]
  v_mul_f32 v112, s56, v112
  v_mul_f32 v113, s56, v113
  v_mul_f32 v114, s56, v114
  v_mul_f32 v115, s56, v115
  v_cvt_pk_bf16_f32 v112, v112, v113
  v_cvt_pk_bf16_f32 v114, v114, v115
  v_perm_b32 v116, v116, v112, s57
  v_perm_b32 v117, v117, v112, s58
  v_perm_b32 v118, v118, v114, s57
  v_perm_b32 v119, v119, v114, s58
  buffer_store_dwordx4 v[116:119], v1, s[64:67], s59 offen offset:0 sc1
  v_mul_f32 v120, s56, v120
  v_mul_f32 v121, s56, v121
  v_mul_f32 v122, s56, v122
  v_mul_f32 v123, s56, v123
  v_cvt_pk_bf16_f32 v120, v120, v121
  v_cvt_pk_bf16_f32 v122, v122, v123
  v_perm_b32 v16, v16, v120, s57
  v_perm_b32 v17, v17, v120, s58
  v_perm_b32 v18, v18, v122, s57
  v_perm_b32 v19, v19, v122, s58
  buffer_store_dwordx4 v[16:19], v1, s[64:67], s59 offen offset:64 sc1
  s_add_u32 s59, s59, 256
  s_add_u32 s38, s38, 256
  s_cmp_lt_u32 s38, 32768
  s_cbranch_scc1 SL2
SL3:
  v_mul_u32_u24 v64, 5120, v126
  v_lshlrev_b32 v118, 2, v124
  v_add_u32 v64, v64, v118
  v_lshl_add_u32 v57, v124, 1, s36
  global_load_ushort v60, v57, s[52:53] offset:0
  global_load_ushort v61, v57, s[52:53] offset:256
  global_load_ushort v62, v57, s[52:53] offset:512
  global_load_ushort v63, v57, s[52:53] offset:768
  s_waitcnt vmcnt(0) lgkmcnt(0)
  s_barrier
  v_lshlrev_b32 v60, 16, v60
  v_mul_f32 v60, 3216550459, v60
  v_lshlrev_b32 v61, 16, v61
  v_mul_f32 v61, 3216550459, v61
  v_lshlrev_b32 v62, 16, v62
  v_mul_f32 v62, 3216550459, v62
  v_lshlrev_b32 v63, 16, v63
  v_mul_f32 v63, 3216550459, v63
  v_add_u32 v65, 65280, v118
  s_mul_i32 s60, s33, 10000
  s_add_u32 s62, s60, 9999
K2S1:
  v_add_u32 v66, s60, v124
  v_cmp_ge_u32 s[58:59], s62, v66
  v_min_u32 v66, s62, v66
  v_lshlrev_b32 v67, 3, v66
  v_lshlrev_b32 v66, 2, v66
  global_load_dword v76, v66, s[46:47]
  global_load_dword v77, v66, s[44:45]
  global_load_dwordx2 v[78:79], v67, s[42:43]
  s_waitcnt vmcnt(0)
  v_and_b32 v66, 0x7f, v76
  v_cmp_eq_u32 vcc, s31, v66
  s_and_b64 s[58:59], s[58:59], vcc
  s_cbranch_scc0 K2S3
K2S2:
  s_ff1_i32_b64 s63, s[58:59]
  s_bitset0_b64 s[58:59], s63
  v_readlane_b32 s64, v76, s63
  v_readlane_b32 s65, v77, s63
  v_readlane_b32 s67, v78, s63
  v_readlane_b32 s69, v79, s63
  s_lshr_b32 s64, s64, 7
  v_lshl_add_u32 v66, s65, 8, v118
  global_load_dword v66, v66, s[14:15] sc1
  v_lshl_add_u32 v67, s64, 6, v64
  ds_read_b32 v67, v67 offset:23808
  v_lshl_add_u32 v70, s64, 9, v65
  s_lshl_b32 s66, s67, 16
  s_and_b32 s67, s67, 0xffff0000
  s_lshl_b32 s68, s69, 16
  s_and_b32 s69, s69, 0xffff0000
  s_waitcnt vmcnt(0) lgkmcnt(0)
  v_lshlrev_b32 v71, 16, v66
  v_add_f32 v67, v67, v71
  v_fmac_f32 v67, s66, v60
  v_fmac_f32 v67, s67, v61
  v_fmac_f32 v67, s68, v62
  v_fmac_f32 v67, s69, v63
  v_exp_f32 v67, v67 clamp
  v_mov_b32 v71, s29
  v_fma_f32 v67, v67, s28, v71
  v_rcp_f32 v67, v67
  s_cmp_lg_u64 s[58:59], 0
  v_mul_f32 v66, v66, v67
  ds_add_f32 v70, v67
  ds_add_f32 v70, v66 offset:256
  s_cbranch_scc1 K2S2
K2S3:
  s_add_u32 s60, s60, 64
  s_cmp_le_u32 s60, s62
  s_cbranch_scc1 K2S1
  s_waitcnt lgkmcnt(0)
  s_barrier
K2S4:
  s_lshl_b32 s43, s33, 9
  v_add_u32 v66, s43, v65
  ds_read_b32 v67, v66
  ds_read_b32 v68, v66 offset:256
  s_lshl_b32 s43, s33, 6
  v_add_u32 v66, s43, v64
  ds_read_b32 v69, v66 offset:44544
  s_and_b32 s43, s33, 15
  s_lshl_b32 s43, s43, 4
  s_lshl_b32 s44, s33, 8
  s_or_b32 s43, s43, s44
  v_xor_b32 v66, s43, v57
  ds_read_u16 v70, v66 offset:0
  s_lshl_b32 s43, s33, 15
  s_add_u32 s43, s43, s35
  v_add_u32 v66, s43, v57
  s_waitcnt lgkmcnt(0)
  v_add_f32 v67, 1158035389, v67
  v_rcp_f32 v67, v67
  v_lshlrev_b32 v70, 16, v70
  v_fmac_f32 v69, v68, v67
  v_max_f32 v69, 0, v69
  v_add_f32 v69, v69, v70
  v_cvt_pk_bf16_f32 v69, v69, v69
  buffer_store_short v69, v66, s[20:23], 0 offen
  s_add_u32 s33, s33, 16
  s_cmp_lt_u32 s33, 80
  s_cbranch_scc1 K2S4
  s_branch K2FI2
.section .rodata,"a"
.p2align 6
.amdhsa_kernel standalone__edge_featured_mpnn_gatedgcn__graph_kernel
  .amdhsa_next_free_vgpr 128
  .amdhsa_next_free_sgpr 80
  .amdhsa_accum_offset 128
  .amdhsa_group_segment_fixed_size 0
  .amdhsa_kernarg_size 96
  .amdhsa_user_sgpr_count 2
  .amdhsa_user_sgpr_kernarg_segment_ptr 1
  .amdhsa_system_sgpr_workgroup_id_x 1
.end_amdhsa_kernel
```
